```python
import torch

def _softmax(x, axis=-1):
    return torch.softmax(x, dim=axis)

def _gelu(x):
    return torch.nn.functional.gelu(x, approximate='tanh')

def _silu(x):
    return torch.nn.functional.silu(x)

def _sigmoid(x):
    return torch.sigmoid(x)

def _layernorm(x, axis=-1, eps=1e-05):
    m = x.mean(dim=axis, keepdim=True)
    v = x.var(dim=axis, keepdim=True, unbiased=False)
    return (x - m) / torch.sqrt(v + eps)

def _scatter_add(tgt, idx, src, axis=0):
    return tgt.clone().index_add_(axis, idx, src)

def _segment_sum(src, seg, n):
    out = torch.zeros((n,) + src.shape[1:], dtype=src.dtype)
    return out.index_add_(0, seg, src)

def _pad(x, pw):
    flat = tuple((v for pair in reversed(pw) for v in pair))
    return torch.nn.functional.pad(x, flat)
kernel_name = 'sequential_preLN__ssm_conv_h3__mixer_gmlp__prompt'

def setup_inputs():

    _w = lambda a: (lambda t: t.to(torch.bfloat16) if t.is_floating_point() else t)(torch.as_tensor(a))

    def _A_setup():
        B, S, D = (1, 2048, 448)
        ks = 4
        return {'q': _w((lambda *s: torch.randn(*s, dtype=torch.bfloat16) * 0.05)(B, S, D)), 'k': _w((lambda *s: torch.randn(*s, dtype=torch.bfloat16) * 0.4)(B, S, D)), 'v': _w((lambda *s: torch.randn(*s, dtype=torch.bfloat16) * 0.4)(B, S, D)), 'shift_k': _w((lambda *s: torch.randn(*s, dtype=torch.bfloat16) * 0.4)(D, ks) * 0.5), 'ssm_k': _w((lambda *s: torch.randn(*s, dtype=torch.bfloat16) * 0.4)(D, S) * (1.0 / S ** 0.5)), 'ssm_D': _w((lambda *s: torch.randn(*s, dtype=torch.bfloat16) * 0.4)(D))}
    _A_in = _A_setup()

    def _B_setup():
        B, S, D, F = (1, 2048, 448, 1792)
        Fh = F // 2
        return {'x': _w((lambda *s: torch.randn(*s, dtype=torch.bfloat16) * 0.05)(B, S, D)), 'w_in': _w((lambda *s: torch.randn(*s, dtype=torch.bfloat16) * 0.4)(D, 2 * Fh)), 'w_sp': _w(0.01 * (lambda *s: torch.randn(*s, dtype=torch.bfloat16) * 0.4)(S, S)), 'b_sp': _w(1.0 + 0.01 * (lambda *s: torch.randn(*s, dtype=torch.bfloat16) * 0.05)(S)), 'w_out': _w((lambda *s: torch.randn(*s, dtype=torch.bfloat16) * 0.05)(Fh, D))}
    _B_in = _B_setup()
    return {'A_q': _A_in['q'], 'A_k': _A_in['k'], 'A_v': _A_in['v'], 'A_shift_k': _A_in['shift_k'], 'A_ssm_k': _A_in['ssm_k'], 'A_ssm_D': _A_in['ssm_D'], 'B_x': _B_in['x'], 'B_w_in': _B_in['w_in'], 'B_w_sp': _B_in['w_sp'], 'B_b_sp': _B_in['b_sp'], 'B_w_out': _B_in['w_out']}

def reference(A_q, A_k, A_v, A_shift_k, A_ssm_k, A_ssm_D, B_x, B_w_in, B_w_sp, B_b_sp, B_w_out):

    def _A_ref(q, k, v, shift_k, ssm_k, ssm_D):
        B, S, D = q.shape
        ks = shift_k.shape[-1]
        k_pad = _pad(k, ((0, 0), (ks - 1, 0), (0, 0)))
        k_shift = torch.zeros_like(k)
        for t in range(ks):
            k_shift = k_shift + k_pad[:, t:t + S, :] * shift_k[:, ks - 1 - t][None, None, :]
        kv = k_shift * v
        L = 2 * S
        kv_pad = _pad(kv, ((0, 0), (0, S), (0, 0)))
        kf_pad = _pad(ssm_k, ((0, 0), (0, S)))
        kv_f = (lambda x, axes=(-2, -1): torch.fft.rfft2(x.float(), dim=axes))(kv_pad[:, None, :, :], axes=(1, 2))
        kf_f = (lambda x, axes=(-2, -1): torch.fft.rfft2(x.float(), dim=axes))(kf_pad[:, None, :], axes=(1, 2))
        kf_f = (lambda x, *d: x.permute(*d))(kf_f, 1, 2, 0)
        y_f = kv_f * kf_f[None, :, :, :]
        y = (lambda x, s, axes=(-2, -1): torch.fft.irfft2(x, s=s, dim=axes).to(torch.bfloat16))(y_f, (1, L), axes=(1, 2))[:, 0, :S, :]
        y = y + kv * ssm_D[None, None, :]
        return q * y

    def _B_ref(x, w_in, w_sp, b_sp, w_out):
        B, S, D = x.shape
        F = w_in.shape[-1]
        Fh = F // 2
        z = _gelu(torch.einsum('bsd,df->bsf', x, w_in))
        z1 = z[..., :Fh].clone()
        z2 = _layernorm(z[..., Fh:], axis=-1)
        g = torch.einsum('ts,bsf->btf', w_sp, z2) + b_sp[None, :, None]
        return torch.einsum('bsf,fd->bsd', z1 * g, w_out)
    x = A_q
    h = x + _A_ref(_layernorm(x, axis=-1), A_k, A_v, A_shift_k, A_ssm_k, A_ssm_D)
    h2 = h + _B_ref(_layernorm(h, axis=-1), B_w_in, B_w_sp, B_b_sp, B_w_out)
    return h2
```

```asm
; @launch kernel=prep_kernel grid=(518,1,1) block=(256,1,1) lds=0
; @launch kernel=conv_kernel grid=(448,1,1) block=(256,1,1) lds=51712
; @launch kernel=hln_kernel grid=(128,1,1) block=(1024,1,1) lds=14592
; @launch kernel=gemm1_kernel grid=(448,1,1) block=(256,1,1) lds=73728
; @launch kernel=ln2_kernel grid=(128,1,1) block=(1024,1,1) lds=43008
; @launch kernel=gemm2_kernel grid=(224,1,1) block=(256,1,1) lds=98304
; @launch kernel=gemm3_kernel grid=(224,1,1) block=(256,1,1) lds=65536
.amdgcn_target "amdgcn-amd-amdhsa--gfx950"
.text
.globl prep_kernel
.p2align 8
.type prep_kernel,@function
prep_kernel:
    s_cmp_ge_u32 s2, 518
    s_cbranch_scc1 prep_kernel_end
    s_load_dwordx16 s[64:79], s[0:1], 0
    s_load_dwordx8 s[80:87], s[0:1], 64
    s_load_dwordx4 s[88:91], s[0:1], 96
    s_waitcnt lgkmcnt(0)
    v_and_b32 v1, 63, v0
    v_lshrrev_b32 v2, 6, v0
    s_cmp_ge_u32 s2, 224
    s_cbranch_scc1 prep_tr
    s_add_u32 s8, s66, 0
    s_addc_u32 s9, s67, 0
    s_mov_b32 s10, 1835008
    s_mov_b32 s11, 0x00020000
    s_add_u32 s12, s68, 0
    s_addc_u32 s13, s69, 0
    s_mov_b32 s14, 1835008
    s_mov_b32 s15, 0x00020000
    s_add_u32 s16, s70, 0
    s_addc_u32 s17, s71, 0
    s_mov_b32 s18, 3584
    s_mov_b32 s19, 0x00020000
    s_add_u32 s20, s90, 0
    s_addc_u32 s21, s91, 0
    s_mov_b32 s22, 1835008
    s_mov_b32 s23, 0x00020000
    s_and_b32 s4, s2, 31
    s_lshr_b32 s5, s2, 5
    s_lshl_b32 s4, s4, 6
    s_lshl_b32 s5, s5, 6
    v_add_u32 v3, s5, v1
    v_lshlrev_b32 v4, 4, v2
    v_add_u32 v4, s4, v4
    v_lshlrev_b32 v5, 3, v3
    buffer_load_dwordx2 v[6:7], v5, s[16:19], 0 offen
    v_lshlrev_b32 v8, 1, v3
    v_subrev_u32 v9, 3, v4
    v_max_i32 v10, 0, v9
    v_mul_u32_u24 v10, 896, v10
    v_add_u32 v10, v10, v8
    buffer_load_ushort v20, v10, s[8:11], 0 offen
    v_subrev_u32 v9, 2, v4
    v_max_i32 v10, 0, v9
    v_mul_u32_u24 v10, 896, v10
    v_add_u32 v10, v10, v8
    buffer_load_ushort v21, v10, s[8:11], 0 offen
    v_subrev_u32 v9, 1, v4
    v_max_i32 v10, 0, v9
    v_mul_u32_u24 v10, 896, v10
    v_add_u32 v10, v10, v8
    buffer_load_ushort v22, v10, s[8:11], 0 offen
    v_add_u32 v9, 0, v4
    v_max_i32 v10, 0, v9
    v_mul_u32_u24 v10, 896, v10
    v_add_u32 v10, v10, v8
    buffer_load_ushort v23, v10, s[8:11], 0 offen
    buffer_load_ushort v40, v10, s[12:15], 0 offen
    v_add_u32 v9, 1, v4
    v_max_i32 v10, 0, v9
    v_mul_u32_u24 v10, 896, v10
    v_add_u32 v10, v10, v8
    buffer_load_ushort v24, v10, s[8:11], 0 offen
    buffer_load_ushort v41, v10, s[12:15], 0 offen
    v_add_u32 v9, 2, v4
    v_max_i32 v10, 0, v9
    v_mul_u32_u24 v10, 896, v10
    v_add_u32 v10, v10, v8
    buffer_load_ushort v25, v10, s[8:11], 0 offen
    buffer_load_ushort v42, v10, s[12:15], 0 offen
    v_add_u32 v9, 3, v4
    v_max_i32 v10, 0, v9
    v_mul_u32_u24 v10, 896, v10
    v_add_u32 v10, v10, v8
    buffer_load_ushort v26, v10, s[8:11], 0 offen
    buffer_load_ushort v43, v10, s[12:15], 0 offen
    v_add_u32 v9, 4, v4
    v_max_i32 v10, 0, v9
    v_mul_u32_u24 v10, 896, v10
    v_add_u32 v10, v10, v8
    buffer_load_ushort v27, v10, s[8:11], 0 offen
    buffer_load_ushort v44, v10, s[12:15], 0 offen
    v_add_u32 v9, 5, v4
    v_max_i32 v10, 0, v9
    v_mul_u32_u24 v10, 896, v10
    v_add_u32 v10, v10, v8
    buffer_load_ushort v28, v10, s[8:11], 0 offen
    buffer_load_ushort v45, v10, s[12:15], 0 offen
    v_add_u32 v9, 6, v4
    v_max_i32 v10, 0, v9
    v_mul_u32_u24 v10, 896, v10
    v_add_u32 v10, v10, v8
    buffer_load_ushort v29, v10, s[8:11], 0 offen
    buffer_load_ushort v46, v10, s[12:15], 0 offen
    v_add_u32 v9, 7, v4
    v_max_i32 v10, 0, v9
    v_mul_u32_u24 v10, 896, v10
    v_add_u32 v10, v10, v8
    buffer_load_ushort v30, v10, s[8:11], 0 offen
    buffer_load_ushort v47, v10, s[12:15], 0 offen
    v_add_u32 v9, 8, v4
    v_max_i32 v10, 0, v9
    v_mul_u32_u24 v10, 896, v10
    v_add_u32 v10, v10, v8
    buffer_load_ushort v31, v10, s[8:11], 0 offen
    buffer_load_ushort v48, v10, s[12:15], 0 offen
    v_add_u32 v9, 9, v4
    v_max_i32 v10, 0, v9
    v_mul_u32_u24 v10, 896, v10
    v_add_u32 v10, v10, v8
    buffer_load_ushort v32, v10, s[8:11], 0 offen
    buffer_load_ushort v49, v10, s[12:15], 0 offen
    v_add_u32 v9, 10, v4
    v_max_i32 v10, 0, v9
    v_mul_u32_u24 v10, 896, v10
    v_add_u32 v10, v10, v8
    buffer_load_ushort v33, v10, s[8:11], 0 offen
    buffer_load_ushort v50, v10, s[12:15], 0 offen
    v_add_u32 v9, 11, v4
    v_max_i32 v10, 0, v9
    v_mul_u32_u24 v10, 896, v10
    v_add_u32 v10, v10, v8
    buffer_load_ushort v34, v10, s[8:11], 0 offen
    buffer_load_ushort v51, v10, s[12:15], 0 offen
    v_add_u32 v9, 12, v4
    v_max_i32 v10, 0, v9
    v_mul_u32_u24 v10, 896, v10
    v_add_u32 v10, v10, v8
    buffer_load_ushort v35, v10, s[8:11], 0 offen
    buffer_load_ushort v52, v10, s[12:15], 0 offen
    v_add_u32 v9, 13, v4
    v_max_i32 v10, 0, v9
    v_mul_u32_u24 v10, 896, v10
    v_add_u32 v10, v10, v8
    buffer_load_ushort v36, v10, s[8:11], 0 offen
    buffer_load_ushort v53, v10, s[12:15], 0 offen
    v_add_u32 v9, 14, v4
    v_max_i32 v10, 0, v9
    v_mul_u32_u24 v10, 896, v10
    v_add_u32 v10, v10, v8
    buffer_load_ushort v37, v10, s[8:11], 0 offen
    buffer_load_ushort v54, v10, s[12:15], 0 offen
    v_add_u32 v9, 15, v4
    v_max_i32 v10, 0, v9
    v_mul_u32_u24 v10, 896, v10
    v_add_u32 v10, v10, v8
    buffer_load_ushort v38, v10, s[8:11], 0 offen
    buffer_load_ushort v55, v10, s[12:15], 0 offen
    s_waitcnt vmcnt(0)
    v_subrev_u32 v9, 3, v4
    v_cmp_le_i32 vcc, 0, v9
    s_nop 1
    v_cndmask_b32 v20, 0, v20, vcc
    v_subrev_u32 v9, 2, v4
    v_cmp_le_i32 vcc, 0, v9
    s_nop 1
    v_cndmask_b32 v21, 0, v21, vcc
    v_subrev_u32 v9, 1, v4
    v_cmp_le_i32 vcc, 0, v9
    s_nop 1
    v_cndmask_b32 v22, 0, v22, vcc
    v_lshlrev_b32 v20, 16, v20
    v_lshlrev_b32 v21, 16, v21
    v_lshlrev_b32 v22, 16, v22
    v_lshlrev_b32 v23, 16, v23
    v_lshlrev_b32 v24, 16, v24
    v_lshlrev_b32 v25, 16, v25
    v_lshlrev_b32 v26, 16, v26
    v_lshlrev_b32 v27, 16, v27
    v_lshlrev_b32 v28, 16, v28
    v_lshlrev_b32 v29, 16, v29
    v_lshlrev_b32 v30, 16, v30
    v_lshlrev_b32 v31, 16, v31
    v_lshlrev_b32 v32, 16, v32
    v_lshlrev_b32 v33, 16, v33
    v_lshlrev_b32 v34, 16, v34
    v_lshlrev_b32 v35, 16, v35
    v_lshlrev_b32 v36, 16, v36
    v_lshlrev_b32 v37, 16, v37
    v_lshlrev_b32 v38, 16, v38
    v_lshlrev_b32 v40, 16, v40
    v_lshlrev_b32 v41, 16, v41
    v_lshlrev_b32 v42, 16, v42
    v_lshlrev_b32 v43, 16, v43
    v_lshlrev_b32 v44, 16, v44
    v_lshlrev_b32 v45, 16, v45
    v_lshlrev_b32 v46, 16, v46
    v_lshlrev_b32 v47, 16, v47
    v_lshlrev_b32 v48, 16, v48
    v_lshlrev_b32 v49, 16, v49
    v_lshlrev_b32 v50, 16, v50
    v_lshlrev_b32 v51, 16, v51
    v_lshlrev_b32 v52, 16, v52
    v_lshlrev_b32 v53, 16, v53
    v_lshlrev_b32 v54, 16, v54
    v_lshlrev_b32 v55, 16, v55
    v_lshlrev_b32 v11, 16, v6
    v_and_b32 v12, 0xffff0000, v6
    v_lshlrev_b32 v13, 16, v7
    v_and_b32 v14, 0xffff0000, v7
    v_mul_f32 v15, v20, v14
    v_cvt_pk_bf16_f32 v9, v15, v15
    v_lshlrev_b32 v15, 16, v9
    v_mul_f32 v16, v21, v13
    v_cvt_pk_bf16_f32 v9, v16, v16
    v_lshlrev_b32 v16, 16, v9
    v_add_f32 v15, v15, v16
    v_cvt_pk_bf16_f32 v9, v15, v15
    v_lshlrev_b32 v15, 16, v9
    v_mul_f32 v16, v22, v12
    v_cvt_pk_bf16_f32 v9, v16, v16
    v_lshlrev_b32 v16, 16, v9
    v_add_f32 v15, v15, v16
    v_cvt_pk_bf16_f32 v9, v15, v15
    v_lshlrev_b32 v15, 16, v9
    v_mul_f32 v16, v23, v11
    v_cvt_pk_bf16_f32 v9, v16, v16
    v_lshlrev_b32 v16, 16, v9
    v_add_f32 v15, v15, v16
    v_cvt_pk_bf16_f32 v9, v15, v15
    v_lshlrev_b32 v15, 16, v9
    v_mul_f32 v60, v15, v40
    v_mul_f32 v15, v21, v14
    v_cvt_pk_bf16_f32 v9, v15, v15
    v_lshlrev_b32 v15, 16, v9
    v_mul_f32 v16, v22, v13
    v_cvt_pk_bf16_f32 v9, v16, v16
    v_lshlrev_b32 v16, 16, v9
    v_add_f32 v15, v15, v16
    v_cvt_pk_bf16_f32 v9, v15, v15
    v_lshlrev_b32 v15, 16, v9
    v_mul_f32 v16, v23, v12
    v_cvt_pk_bf16_f32 v9, v16, v16
    v_lshlrev_b32 v16, 16, v9
    v_add_f32 v15, v15, v16
    v_cvt_pk_bf16_f32 v9, v15, v15
    v_lshlrev_b32 v15, 16, v9
    v_mul_f32 v16, v24, v11
    v_cvt_pk_bf16_f32 v9, v16, v16
    v_lshlrev_b32 v16, 16, v9
    v_add_f32 v15, v15, v16
    v_cvt_pk_bf16_f32 v9, v15, v15
    v_lshlrev_b32 v15, 16, v9
    v_mul_f32 v61, v15, v41
    v_mul_f32 v15, v22, v14
    v_cvt_pk_bf16_f32 v9, v15, v15
    v_lshlrev_b32 v15, 16, v9
    v_mul_f32 v16, v23, v13
    v_cvt_pk_bf16_f32 v9, v16, v16
    v_lshlrev_b32 v16, 16, v9
    v_add_f32 v15, v15, v16
    v_cvt_pk_bf16_f32 v9, v15, v15
    v_lshlrev_b32 v15, 16, v9
    v_mul_f32 v16, v24, v12
    v_cvt_pk_bf16_f32 v9, v16, v16
    v_lshlrev_b32 v16, 16, v9
    v_add_f32 v15, v15, v16
    v_cvt_pk_bf16_f32 v9, v15, v15
    v_lshlrev_b32 v15, 16, v9
    v_mul_f32 v16, v25, v11
    v_cvt_pk_bf16_f32 v9, v16, v16
    v_lshlrev_b32 v16, 16, v9
    v_add_f32 v15, v15, v16
    v_cvt_pk_bf16_f32 v9, v15, v15
    v_lshlrev_b32 v15, 16, v9
    v_mul_f32 v62, v15, v42
    v_mul_f32 v15, v23, v14
    v_cvt_pk_bf16_f32 v9, v15, v15
    v_lshlrev_b32 v15, 16, v9
    v_mul_f32 v16, v24, v13
    v_cvt_pk_bf16_f32 v9, v16, v16
    v_lshlrev_b32 v16, 16, v9
    v_add_f32 v15, v15, v16
    v_cvt_pk_bf16_f32 v9, v15, v15
    v_lshlrev_b32 v15, 16, v9
    v_mul_f32 v16, v25, v12
    v_cvt_pk_bf16_f32 v9, v16, v16
    v_lshlrev_b32 v16, 16, v9
    v_add_f32 v15, v15, v16
    v_cvt_pk_bf16_f32 v9, v15, v15
    v_lshlrev_b32 v15, 16, v9
    v_mul_f32 v16, v26, v11
    v_cvt_pk_bf16_f32 v9, v16, v16
    v_lshlrev_b32 v16, 16, v9
    v_add_f32 v15, v15, v16
    v_cvt_pk_bf16_f32 v9, v15, v15
    v_lshlrev_b32 v15, 16, v9
    v_mul_f32 v63, v15, v43
    v_mul_f32 v15, v24, v14
    v_cvt_pk_bf16_f32 v9, v15, v15
    v_lshlrev_b32 v15, 16, v9
    v_mul_f32 v16, v25, v13
    v_cvt_pk_bf16_f32 v9, v16, v16
    v_lshlrev_b32 v16, 16, v9
    v_add_f32 v15, v15, v16
    v_cvt_pk_bf16_f32 v9, v15, v15
    v_lshlrev_b32 v15, 16, v9
    v_mul_f32 v16, v26, v12
    v_cvt_pk_bf16_f32 v9, v16, v16
    v_lshlrev_b32 v16, 16, v9
    v_add_f32 v15, v15, v16
    v_cvt_pk_bf16_f32 v9, v15, v15
    v_lshlrev_b32 v15, 16, v9
    v_mul_f32 v16, v27, v11
    v_cvt_pk_bf16_f32 v9, v16, v16
    v_lshlrev_b32 v16, 16, v9
    v_add_f32 v15, v15, v16
    v_cvt_pk_bf16_f32 v9, v15, v15
    v_lshlrev_b32 v15, 16, v9
    v_mul_f32 v64, v15, v44
    v_mul_f32 v15, v25, v14
    v_cvt_pk_bf16_f32 v9, v15, v15
    v_lshlrev_b32 v15, 16, v9
    v_mul_f32 v16, v26, v13
    v_cvt_pk_bf16_f32 v9, v16, v16
    v_lshlrev_b32 v16, 16, v9
    v_add_f32 v15, v15, v16
    v_cvt_pk_bf16_f32 v9, v15, v15
    v_lshlrev_b32 v15, 16, v9
    v_mul_f32 v16, v27, v12
    v_cvt_pk_bf16_f32 v9, v16, v16
    v_lshlrev_b32 v16, 16, v9
    v_add_f32 v15, v15, v16
    v_cvt_pk_bf16_f32 v9, v15, v15
    v_lshlrev_b32 v15, 16, v9
    v_mul_f32 v16, v28, v11
    v_cvt_pk_bf16_f32 v9, v16, v16
    v_lshlrev_b32 v16, 16, v9
    v_add_f32 v15, v15, v16
    v_cvt_pk_bf16_f32 v9, v15, v15
    v_lshlrev_b32 v15, 16, v9
    v_mul_f32 v65, v15, v45
    v_mul_f32 v15, v26, v14
    v_cvt_pk_bf16_f32 v9, v15, v15
    v_lshlrev_b32 v15, 16, v9
    v_mul_f32 v16, v27, v13
    v_cvt_pk_bf16_f32 v9, v16, v16
    v_lshlrev_b32 v16, 16, v9
    v_add_f32 v15, v15, v16
    v_cvt_pk_bf16_f32 v9, v15, v15
    v_lshlrev_b32 v15, 16, v9
    v_mul_f32 v16, v28, v12
    v_cvt_pk_bf16_f32 v9, v16, v16
    v_lshlrev_b32 v16, 16, v9
    v_add_f32 v15, v15, v16
    v_cvt_pk_bf16_f32 v9, v15, v15
    v_lshlrev_b32 v15, 16, v9
    v_mul_f32 v16, v29, v11
    v_cvt_pk_bf16_f32 v9, v16, v16
    v_lshlrev_b32 v16, 16, v9
    v_add_f32 v15, v15, v16
    v_cvt_pk_bf16_f32 v9, v15, v15
    v_lshlrev_b32 v15, 16, v9
    v_mul_f32 v66, v15, v46
    v_mul_f32 v15, v27, v14
    v_cvt_pk_bf16_f32 v9, v15, v15
    v_lshlrev_b32 v15, 16, v9
    v_mul_f32 v16, v28, v13
    v_cvt_pk_bf16_f32 v9, v16, v16
    v_lshlrev_b32 v16, 16, v9
    v_add_f32 v15, v15, v16
    v_cvt_pk_bf16_f32 v9, v15, v15
    v_lshlrev_b32 v15, 16, v9
    v_mul_f32 v16, v29, v12
    v_cvt_pk_bf16_f32 v9, v16, v16
    v_lshlrev_b32 v16, 16, v9
    v_add_f32 v15, v15, v16
    v_cvt_pk_bf16_f32 v9, v15, v15
    v_lshlrev_b32 v15, 16, v9
    v_mul_f32 v16, v30, v11
    v_cvt_pk_bf16_f32 v9, v16, v16
    v_lshlrev_b32 v16, 16, v9
    v_add_f32 v15, v15, v16
    v_cvt_pk_bf16_f32 v9, v15, v15
    v_lshlrev_b32 v15, 16, v9
    v_mul_f32 v67, v15, v47
    v_mul_f32 v15, v28, v14
    v_cvt_pk_bf16_f32 v9, v15, v15
    v_lshlrev_b32 v15, 16, v9
    v_mul_f32 v16, v29, v13
    v_cvt_pk_bf16_f32 v9, v16, v16
    v_lshlrev_b32 v16, 16, v9
    v_add_f32 v15, v15, v16
    v_cvt_pk_bf16_f32 v9, v15, v15
    v_lshlrev_b32 v15, 16, v9
    v_mul_f32 v16, v30, v12
    v_cvt_pk_bf16_f32 v9, v16, v16
    v_lshlrev_b32 v16, 16, v9
    v_add_f32 v15, v15, v16
    v_cvt_pk_bf16_f32 v9, v15, v15
    v_lshlrev_b32 v15, 16, v9
    v_mul_f32 v16, v31, v11
    v_cvt_pk_bf16_f32 v9, v16, v16
    v_lshlrev_b32 v16, 16, v9
    v_add_f32 v15, v15, v16
    v_cvt_pk_bf16_f32 v9, v15, v15
    v_lshlrev_b32 v15, 16, v9
    v_mul_f32 v68, v15, v48
    v_mul_f32 v15, v29, v14
    v_cvt_pk_bf16_f32 v9, v15, v15
    v_lshlrev_b32 v15, 16, v9
    v_mul_f32 v16, v30, v13
    v_cvt_pk_bf16_f32 v9, v16, v16
    v_lshlrev_b32 v16, 16, v9
    v_add_f32 v15, v15, v16
    v_cvt_pk_bf16_f32 v9, v15, v15
    v_lshlrev_b32 v15, 16, v9
    v_mul_f32 v16, v31, v12
    v_cvt_pk_bf16_f32 v9, v16, v16
    v_lshlrev_b32 v16, 16, v9
    v_add_f32 v15, v15, v16
    v_cvt_pk_bf16_f32 v9, v15, v15
    v_lshlrev_b32 v15, 16, v9
    v_mul_f32 v16, v32, v11
    v_cvt_pk_bf16_f32 v9, v16, v16
    v_lshlrev_b32 v16, 16, v9
    v_add_f32 v15, v15, v16
    v_cvt_pk_bf16_f32 v9, v15, v15
    v_lshlrev_b32 v15, 16, v9
    v_mul_f32 v69, v15, v49
    v_mul_f32 v15, v30, v14
    v_cvt_pk_bf16_f32 v9, v15, v15
    v_lshlrev_b32 v15, 16, v9
    v_mul_f32 v16, v31, v13
    v_cvt_pk_bf16_f32 v9, v16, v16
    v_lshlrev_b32 v16, 16, v9
    v_add_f32 v15, v15, v16
    v_cvt_pk_bf16_f32 v9, v15, v15
    v_lshlrev_b32 v15, 16, v9
    v_mul_f32 v16, v32, v12
    v_cvt_pk_bf16_f32 v9, v16, v16
    v_lshlrev_b32 v16, 16, v9
    v_add_f32 v15, v15, v16
    v_cvt_pk_bf16_f32 v9, v15, v15
    v_lshlrev_b32 v15, 16, v9
    v_mul_f32 v16, v33, v11
    v_cvt_pk_bf16_f32 v9, v16, v16
    v_lshlrev_b32 v16, 16, v9
    v_add_f32 v15, v15, v16
    v_cvt_pk_bf16_f32 v9, v15, v15
    v_lshlrev_b32 v15, 16, v9
    v_mul_f32 v70, v15, v50
    v_mul_f32 v15, v31, v14
    v_cvt_pk_bf16_f32 v9, v15, v15
    v_lshlrev_b32 v15, 16, v9
    v_mul_f32 v16, v32, v13
    v_cvt_pk_bf16_f32 v9, v16, v16
    v_lshlrev_b32 v16, 16, v9
    v_add_f32 v15, v15, v16
    v_cvt_pk_bf16_f32 v9, v15, v15
    v_lshlrev_b32 v15, 16, v9
    v_mul_f32 v16, v33, v12
    v_cvt_pk_bf16_f32 v9, v16, v16
    v_lshlrev_b32 v16, 16, v9
    v_add_f32 v15, v15, v16
    v_cvt_pk_bf16_f32 v9, v15, v15
    v_lshlrev_b32 v15, 16, v9
    v_mul_f32 v16, v34, v11
    v_cvt_pk_bf16_f32 v9, v16, v16
    v_lshlrev_b32 v16, 16, v9
    v_add_f32 v15, v15, v16
    v_cvt_pk_bf16_f32 v9, v15, v15
    v_lshlrev_b32 v15, 16, v9
    v_mul_f32 v71, v15, v51
    v_mul_f32 v15, v32, v14
    v_cvt_pk_bf16_f32 v9, v15, v15
    v_lshlrev_b32 v15, 16, v9
    v_mul_f32 v16, v33, v13
    v_cvt_pk_bf16_f32 v9, v16, v16
    v_lshlrev_b32 v16, 16, v9
    v_add_f32 v15, v15, v16
    v_cvt_pk_bf16_f32 v9, v15, v15
    v_lshlrev_b32 v15, 16, v9
    v_mul_f32 v16, v34, v12
    v_cvt_pk_bf16_f32 v9, v16, v16
    v_lshlrev_b32 v16, 16, v9
    v_add_f32 v15, v15, v16
    v_cvt_pk_bf16_f32 v9, v15, v15
    v_lshlrev_b32 v15, 16, v9
    v_mul_f32 v16, v35, v11
    v_cvt_pk_bf16_f32 v9, v16, v16
    v_lshlrev_b32 v16, 16, v9
    v_add_f32 v15, v15, v16
    v_cvt_pk_bf16_f32 v9, v15, v15
    v_lshlrev_b32 v15, 16, v9
    v_mul_f32 v72, v15, v52
    v_mul_f32 v15, v33, v14
    v_cvt_pk_bf16_f32 v9, v15, v15
    v_lshlrev_b32 v15, 16, v9
    v_mul_f32 v16, v34, v13
    v_cvt_pk_bf16_f32 v9, v16, v16
    v_lshlrev_b32 v16, 16, v9
    v_add_f32 v15, v15, v16
    v_cvt_pk_bf16_f32 v9, v15, v15
    v_lshlrev_b32 v15, 16, v9
    v_mul_f32 v16, v35, v12
    v_cvt_pk_bf16_f32 v9, v16, v16
    v_lshlrev_b32 v16, 16, v9
    v_add_f32 v15, v15, v16
    v_cvt_pk_bf16_f32 v9, v15, v15
    v_lshlrev_b32 v15, 16, v9
    v_mul_f32 v16, v36, v11
    v_cvt_pk_bf16_f32 v9, v16, v16
    v_lshlrev_b32 v16, 16, v9
    v_add_f32 v15, v15, v16
    v_cvt_pk_bf16_f32 v9, v15, v15
    v_lshlrev_b32 v15, 16, v9
    v_mul_f32 v73, v15, v53
    v_mul_f32 v15, v34, v14
    v_cvt_pk_bf16_f32 v9, v15, v15
    v_lshlrev_b32 v15, 16, v9
    v_mul_f32 v16, v35, v13
    v_cvt_pk_bf16_f32 v9, v16, v16
    v_lshlrev_b32 v16, 16, v9
    v_add_f32 v15, v15, v16
    v_cvt_pk_bf16_f32 v9, v15, v15
    v_lshlrev_b32 v15, 16, v9
    v_mul_f32 v16, v36, v12
    v_cvt_pk_bf16_f32 v9, v16, v16
    v_lshlrev_b32 v16, 16, v9
    v_add_f32 v15, v15, v16
    v_cvt_pk_bf16_f32 v9, v15, v15
    v_lshlrev_b32 v15, 16, v9
    v_mul_f32 v16, v37, v11
    v_cvt_pk_bf16_f32 v9, v16, v16
    v_lshlrev_b32 v16, 16, v9
    v_add_f32 v15, v15, v16
    v_cvt_pk_bf16_f32 v9, v15, v15
    v_lshlrev_b32 v15, 16, v9
    v_mul_f32 v74, v15, v54
    v_mul_f32 v15, v35, v14
    v_cvt_pk_bf16_f32 v9, v15, v15
    v_lshlrev_b32 v15, 16, v9
    v_mul_f32 v16, v36, v13
    v_cvt_pk_bf16_f32 v9, v16, v16
    v_lshlrev_b32 v16, 16, v9
    v_add_f32 v15, v15, v16
    v_cvt_pk_bf16_f32 v9, v15, v15
    v_lshlrev_b32 v15, 16, v9
    v_mul_f32 v16, v37, v12
    v_cvt_pk_bf16_f32 v9, v16, v16
    v_lshlrev_b32 v16, 16, v9
    v_add_f32 v15, v15, v16
    v_cvt_pk_bf16_f32 v9, v15, v15
    v_lshlrev_b32 v15, 16, v9
    v_mul_f32 v16, v38, v11
    v_cvt_pk_bf16_f32 v9, v16, v16
    v_lshlrev_b32 v16, 16, v9
    v_add_f32 v15, v15, v16
    v_cvt_pk_bf16_f32 v9, v15, v15
    v_lshlrev_b32 v15, 16, v9
    v_mul_f32 v75, v15, v55
    v_cvt_pk_bf16_f32 v80, v60, v61
    v_cvt_pk_bf16_f32 v81, v62, v63
    v_cvt_pk_bf16_f32 v82, v64, v65
    v_cvt_pk_bf16_f32 v83, v66, v67
    v_cvt_pk_bf16_f32 v84, v68, v69
    v_cvt_pk_bf16_f32 v85, v70, v71
    v_cvt_pk_bf16_f32 v86, v72, v73
    v_cvt_pk_bf16_f32 v87, v74, v75
    v_lshlrev_b32 v9, 12, v3
    v_lshlrev_b32 v10, 1, v4
    v_add_u32 v9, v9, v10
    buffer_store_dwordx4 v[80:83], v9, s[20:23], 0 offen
    buffer_store_dwordx4 v[84:87], v9, s[20:23], 0 offen offset:16
    s_branch prep_kernel_end
prep_tr:
    s_cmp_ge_u32 s2, 420
    s_cbranch_scc1 prep_tr2
    s_add_u32 s8, s78, 0
    s_addc_u32 s9, s79, 0
    s_mov_b32 s10, 1605632
    s_mov_b32 s11, 0x00020000
    s_add_u32 s20, s90, 8388608
    s_addc_u32 s21, s91, 0
    s_mov_b32 s22, 1605632
    s_mov_b32 s23, 0x00020000
    s_sub_u32 s4, s2, 224
    s_mul_i32 s5, s4, 9363
    s_lshr_b32 s5, s5, 16
    s_mul_i32 s6, s5, 7
    s_sub_u32 s6, s4, s6
    s_mov_b32 s24, 3584
    s_mov_b32 s25, 896
    s_branch prep_trc
prep_tr2:
    s_add_u32 s8, s84, 0
    s_addc_u32 s9, s85, 0
    s_mov_b32 s10, 802816
    s_mov_b32 s11, 0x00020000
    s_add_u32 s20, s90, 10485760
    s_addc_u32 s21, s91, 0
    s_mov_b32 s22, 802816
    s_mov_b32 s23, 0x00020000
    s_sub_u32 s4, s2, 420
    s_mul_i32 s5, s4, 4682
    s_lshr_b32 s5, s5, 16
    s_mul_i32 s6, s5, 14
    s_sub_u32 s6, s4, s6
    s_mov_b32 s24, 896
    s_mov_b32 s25, 1792
prep_trc:
    s_lshl_b32 s5, s5, 6
    s_lshl_b32 s6, s6, 6
    v_add_u32 v3, s5, v1
    v_lshlrev_b32 v4, 4, v2
    v_add_u32 v4, s6, v4
    v_mul_lo_u32 v5, v4, s24
    v_lshlrev_b32 v6, 1, v3
    v_add_u32 v5, v5, v6
    buffer_load_ushort v20, v5, s[8:11], 0 offen
    v_add_u32 v5, s24, v5
    buffer_load_ushort v21, v5, s[8:11], 0 offen
    v_add_u32 v5, s24, v5
    buffer_load_ushort v22, v5, s[8:11], 0 offen
    v_add_u32 v5, s24, v5
    buffer_load_ushort v23, v5, s[8:11], 0 offen
    v_add_u32 v5, s24, v5
    buffer_load_ushort v24, v5, s[8:11], 0 offen
    v_add_u32 v5, s24, v5
    buffer_load_ushort v25, v5, s[8:11], 0 offen
    v_add_u32 v5, s24, v5
    buffer_load_ushort v26, v5, s[8:11], 0 offen
    v_add_u32 v5, s24, v5
    buffer_load_ushort v27, v5, s[8:11], 0 offen
    v_add_u32 v5, s24, v5
    buffer_load_ushort v28, v5, s[8:11], 0 offen
    v_add_u32 v5, s24, v5
    buffer_load_ushort v29, v5, s[8:11], 0 offen
    v_add_u32 v5, s24, v5
    buffer_load_ushort v30, v5, s[8:11], 0 offen
    v_add_u32 v5, s24, v5
    buffer_load_ushort v31, v5, s[8:11], 0 offen
    v_add_u32 v5, s24, v5
    buffer_load_ushort v32, v5, s[8:11], 0 offen
    v_add_u32 v5, s24, v5
    buffer_load_ushort v33, v5, s[8:11], 0 offen
    v_add_u32 v5, s24, v5
    buffer_load_ushort v34, v5, s[8:11], 0 offen
    v_add_u32 v5, s24, v5
    buffer_load_ushort v35, v5, s[8:11], 0 offen
    v_add_u32 v5, s24, v5
    s_waitcnt vmcnt(0)
    v_lshl_or_b32 v40, v21, 16, v20
    v_lshl_or_b32 v41, v23, 16, v22
    v_lshl_or_b32 v42, v25, 16, v24
    v_lshl_or_b32 v43, v27, 16, v26
    v_lshl_or_b32 v44, v29, 16, v28
    v_lshl_or_b32 v45, v31, 16, v30
    v_lshl_or_b32 v46, v33, 16, v32
    v_lshl_or_b32 v47, v35, 16, v34
    v_mul_lo_u32 v5, v3, s25
    v_lshlrev_b32 v6, 1, v4
    v_add_u32 v5, v5, v6
    buffer_store_dwordx4 v[40:43], v5, s[20:23], 0 offen
    buffer_store_dwordx4 v[44:47], v5, s[20:23], 0 offen offset:16
prep_kernel_end:
    s_endpgm
.globl conv_kernel
.p2align 8
.type conv_kernel,@function
conv_kernel:
    s_cmp_ge_u32 s2, 448
    s_cbranch_scc1 conv_kernel_end
    s_load_dwordx16 s[64:79], s[0:1], 0
    s_load_dwordx8 s[80:87], s[0:1], 64
    s_load_dwordx4 s[88:91], s[0:1], 96
    s_waitcnt lgkmcnt(0)
    s_add_u32 s8, s90, 0
    s_addc_u32 s9, s91, 0
    s_mov_b32 s10, 1835008
    s_mov_b32 s11, 0x00020000
    s_add_u32 s12, s72, 0
    s_addc_u32 s13, s73, 0
    s_mov_b32 s14, 1835008
    s_mov_b32 s15, 0x00020000
    s_add_u32 s16, s74, 0
    s_addc_u32 s17, s75, 0
    s_mov_b32 s18, 896
    s_mov_b32 s19, 0x00020000
    s_add_u32 s20, s90, 2097152
    s_addc_u32 s21, s91, 0
    s_mov_b32 s22, 1835008
    s_mov_b32 s23, 0x00020000
    s_lshl_b32 s4, s2, 12
    v_lshlrev_b32 v1, 4, v0
    buffer_load_dwordx4 v[4:7], v1, s[8:11], s4 offen
    buffer_load_dwordx4 v[48:51], v1, s[12:15], s4 offen
    buffer_load_dwordx4 v[52:55], v1, s[12:15], s4 offen offset:16
    s_lshl_b32 s5, s2, 1
    v_mov_b32 v2, s5
    buffer_load_ushort v3, v2, s[16:19], 0 offen
    v_mov_b32 v12, 0
    v_mov_b32 v13, 0
    v_mov_b32 v14, 0
    v_mov_b32 v15, 0
    ds_write_b128 v1, v[12:15] offset:0
    ds_write_b128 v1, v[12:15] offset:43520
    ds_write_b128 v1, v[12:15] offset:47616
    v_cmp_gt_u32 vcc, 64, v0
    s_and_saveexec_b64 s[24:25], vcc
    ds_write_b128 v1, v[12:15] offset:4096
    v_lshrrev_b32 v16, 2, v0
    v_mul_u32_u24 v16, 4160, v16
    v_and_b32 v17, 3, v0
    v_lshlrev_b32 v17, 4, v17
    v_add_u32 v16, v16, v17
    v_cmp_gt_u32 vcc, 32, v0
    s_and_b64 exec, exec, vcc
    ds_write_b128 v16, v[12:15] offset:10240
    s_mov_b64 exec, s[24:25]
    s_waitcnt vmcnt(0) lgkmcnt(0)
    s_barrier
    v_alignbit_b32 v12, v7, v7, 16
    v_alignbit_b32 v13, v6, v6, 16
    v_alignbit_b32 v14, v5, v5, 16
    v_alignbit_b32 v15, v4, v4, 16
    v_lshrrev_b32 v16, 2, v0
    v_add_u32 v16, 64, v16
    v_mul_u32_u24 v16, 80, v16
    v_and_b32 v17, 3, v0
    v_lshlrev_b32 v17, 4, v17
    v_sub_u32 v17, 48, v17
    v_add_u32 v16, v16, v17
    ds_write_b128 v16, v[12:15] offset:0
    v_lshlrev_b32 v16, 4, v0
    ds_write_b128 v16, v[48:51] offset:10304
    v_alignbit_b32 v56, v49, v48, 16
    v_alignbit_b32 v57, v50, v49, 16
    v_alignbit_b32 v58, v51, v50, 16
    v_alignbit_b32 v59, v52, v51, 16
    ds_write_b128 v16, v[56:59] offset:14464
    v_mov_b32 v60, v49
    v_mov_b32 v61, v50
    v_mov_b32 v62, v51
    v_mov_b32 v63, v52
    ds_write_b128 v16, v[60:63] offset:18624
    v_alignbit_b32 v56, v50, v49, 16
    v_alignbit_b32 v57, v51, v50, 16
    v_alignbit_b32 v58, v52, v51, 16
    v_alignbit_b32 v59, v53, v52, 16
    ds_write_b128 v16, v[56:59] offset:22784
    ds_write_b128 v16, v[50:53] offset:26944
    v_alignbit_b32 v56, v51, v50, 16
    v_alignbit_b32 v57, v52, v51, 16
    v_alignbit_b32 v58, v53, v52, 16
    v_alignbit_b32 v59, v54, v53, 16
    ds_write_b128 v16, v[56:59] offset:31104
    v_mov_b32 v60, v51
    v_mov_b32 v61, v52
    v_mov_b32 v62, v53
    v_mov_b32 v63, v54
    ds_write_b128 v16, v[60:63] offset:35264
    v_alignbit_b32 v56, v52, v51, 16
    v_alignbit_b32 v57, v53, v52, 16
    v_alignbit_b32 v58, v54, v53, 16
    v_alignbit_b32 v59, v55, v54, 16
    ds_write_b128 v16, v[56:59] offset:39424
    v_cmp_eq_u32 vcc, 0, v0
    s_and_saveexec_b64 s[24:25], vcc
    ds_write_b16 v16, v48 offset:14462
    ds_write_b16 v16, v48 offset:18620
    ds_write_b16 v16, v48 offset:22778
    ds_write_b16 v16, v48 offset:26936
    ds_write_b16 v16, v48 offset:31094
    ds_write_b16 v16, v48 offset:35252
    ds_write_b16 v16, v48 offset:39410
    v_lshrrev_b32 v17, 16, v48
    ds_write_b16 v16, v17 offset:18622
    ds_write_b16 v16, v17 offset:22780
    ds_write_b16 v16, v17 offset:26938
    ds_write_b16 v16, v17 offset:31096
    ds_write_b16 v16, v17 offset:35254
    ds_write_b16 v16, v17 offset:39412
    ds_write_b16 v16, v49 offset:22782
    ds_write_b16 v16, v49 offset:26940
    ds_write_b16 v16, v49 offset:31098
    ds_write_b16 v16, v49 offset:35256
    ds_write_b16 v16, v49 offset:39414
    v_lshrrev_b32 v17, 16, v49
    ds_write_b16 v16, v17 offset:26942
    ds_write_b16 v16, v17 offset:31100
    ds_write_b16 v16, v17 offset:35258
    ds_write_b16 v16, v17 offset:39416
    ds_write_b16 v16, v50 offset:31102
    ds_write_b16 v16, v50 offset:35260
    ds_write_b16 v16, v50 offset:39418
    v_lshrrev_b32 v17, 16, v50
    ds_write_b16 v16, v17 offset:35262
    ds_write_b16 v16, v17 offset:39420
    ds_write_b16 v16, v51 offset:39422
    s_mov_b64 exec, s[24:25]
    s_waitcnt lgkmcnt(0)
    s_barrier
    v_and_b32 v16, 31, v0
    v_bfe_u32 v17, v0, 5, 1
    v_lshrrev_b32 v18, 6, v0
    v_add_u32 v19, 36, v16
    v_sub_u32 v19, v19, v18
    v_mul_u32_u24 v19, 80, v19
    v_lshlrev_b32 v20, 4, v17
    v_add_u32 v19, v19, v20
    v_add_u32 v21, 1, v16
    v_and_b32 v22, 7, v21
    v_mul_u32_u24 v22, 4160, v22
    v_lshrrev_b32 v21, 3, v21
    v_add_u32 v21, v21, v17
    v_lshlrev_b32 v21, 4, v21
    v_add_u32 v22, v22, v21
    v_lshlrev_b32 v21, 6, v18
    v_add_u32 v22, v22, v21
    v_mov_b32 v80, 0
    v_mov_b32 v81, 0
    v_mov_b32 v82, 0
    v_mov_b32 v83, 0
    v_mov_b32 v84, 0
    v_mov_b32 v85, 0
    v_mov_b32 v86, 0
    v_mov_b32 v87, 0
    v_mov_b32 v88, 0
    v_mov_b32 v89, 0
    v_mov_b32 v90, 0
    v_mov_b32 v91, 0
    v_mov_b32 v92, 0
    v_mov_b32 v93, 0
    v_mov_b32 v94, 0
    v_mov_b32 v95, 0
    v_mov_b32 v96, 0
    v_mov_b32 v97, 0
    v_mov_b32 v98, 0
    v_mov_b32 v99, 0
    v_mov_b32 v100, 0
    v_mov_b32 v101, 0
    v_mov_b32 v102, 0
    v_mov_b32 v103, 0
    v_mov_b32 v104, 0
    v_mov_b32 v105, 0
    v_mov_b32 v106, 0
    v_mov_b32 v107, 0
    v_mov_b32 v108, 0
    v_mov_b32 v109, 0
    v_mov_b32 v110, 0
    v_mov_b32 v111, 0
    ds_read_b128 v[24:27], v22 offset:10240
    ds_read_b128 v[32:35], v19 offset:4800
    ds_read_b128 v[28:31], v22 offset:10272
    ds_read_b128 v[36:39], v19 offset:4832
    ds_read_b128 v[40:43], v19 offset:2240
    ds_read_b128 v[44:47], v19 offset:2272
    ds_read_b128 v[48:51], v22 offset:10496
    ds_read_b128 v[56:59], v19 offset:4480
    ds_read_b128 v[52:55], v22 offset:10528
    ds_read_b128 v[60:63], v19 offset:4512
    ds_read_b128 v[64:67], v19 offset:1920
    ds_read_b128 v[68:71], v19 offset:1952
    s_waitcnt lgkmcnt(6)
    v_mfma_f32_32x32x16_bf16 v[96:111], v[32:35], v[24:27], v[96:111]
    v_mfma_f32_32x32x16_bf16 v[80:95], v[40:43], v[24:27], v[80:95]
    v_mfma_f32_32x32x16_bf16 v[96:111], v[36:39], v[28:31], v[96:111]
    v_mfma_f32_32x32x16_bf16 v[80:95], v[44:47], v[28:31], v[80:95]
    ds_read_b128 v[24:27], v22 offset:10752
    ds_read_b128 v[32:35], v19 offset:4160
    ds_read_b128 v[28:31], v22 offset:10784
    ds_read_b128 v[36:39], v19 offset:4192
    ds_read_b128 v[40:43], v19 offset:1600
    ds_read_b128 v[44:47], v19 offset:1632
    s_waitcnt lgkmcnt(6)
    v_mfma_f32_32x32x16_bf16 v[96:111], v[56:59], v[48:51], v[96:111]
    v_mfma_f32_32x32x16_bf16 v[80:95], v[64:67], v[48:51], v[80:95]
    v_mfma_f32_32x32x16_bf16 v[96:111], v[60:63], v[52:55], v[96:111]
    v_mfma_f32_32x32x16_bf16 v[80:95], v[68:71], v[52:55], v[80:95]
    ds_read_b128 v[48:51], v22 offset:11008
    ds_read_b128 v[56:59], v19 offset:3840
    ds_read_b128 v[52:55], v22 offset:11040
    ds_read_b128 v[60:63], v19 offset:3872
    ds_read_b128 v[64:67], v19 offset:1280
    ds_read_b128 v[68:71], v19 offset:1312
    s_waitcnt lgkmcnt(6)
    v_mfma_f32_32x32x16_bf16 v[96:111], v[32:35], v[24:27], v[96:111]
    v_mfma_f32_32x32x16_bf16 v[80:95], v[40:43], v[24:27], v[80:95]
    v_mfma_f32_32x32x16_bf16 v[96:111], v[36:39], v[28:31], v[96:111]
    v_mfma_f32_32x32x16_bf16 v[80:95], v[44:47], v[28:31], v[80:95]
    ds_read_b128 v[24:27], v22 offset:11264
    ds_read_b128 v[32:35], v19 offset:3520
    ds_read_b128 v[28:31], v22 offset:11296
    ds_read_b128 v[36:39], v19 offset:3552
    ds_read_b128 v[40:43], v19 offset:960
    ds_read_b128 v[44:47], v19 offset:992
    s_waitcnt lgkmcnt(6)
    v_mfma_f32_32x32x16_bf16 v[96:111], v[56:59], v[48:51], v[96:111]
    v_mfma_f32_32x32x16_bf16 v[80:95], v[64:67], v[48:51], v[80:95]
    v_mfma_f32_32x32x16_bf16 v[96:111], v[60:63], v[52:55], v[96:111]
    v_mfma_f32_32x32x16_bf16 v[80:95], v[68:71], v[52:55], v[80:95]
    ds_read_b128 v[48:51], v22 offset:11520
    ds_read_b128 v[56:59], v19 offset:3200
    ds_read_b128 v[52:55], v22 offset:11552
    ds_read_b128 v[60:63], v19 offset:3232
    ds_read_b128 v[64:67], v19 offset:640
    ds_read_b128 v[68:71], v19 offset:672
    s_waitcnt lgkmcnt(6)
    v_mfma_f32_32x32x16_bf16 v[96:111], v[32:35], v[24:27], v[96:111]
    v_mfma_f32_32x32x16_bf16 v[80:95], v[40:43], v[24:27], v[80:95]
    v_mfma_f32_32x32x16_bf16 v[96:111], v[36:39], v[28:31], v[96:111]
    v_mfma_f32_32x32x16_bf16 v[80:95], v[44:47], v[28:31], v[80:95]
    ds_read_b128 v[24:27], v22 offset:11776
    ds_read_b128 v[32:35], v19 offset:2880
    ds_read_b128 v[28:31], v22 offset:11808
    ds_read_b128 v[36:39], v19 offset:2912
    ds_read_b128 v[40:43], v19 offset:320
    ds_read_b128 v[44:47], v19 offset:352
    s_waitcnt lgkmcnt(6)
    v_mfma_f32_32x32x16_bf16 v[96:111], v[56:59], v[48:51], v[96:111]
    v_mfma_f32_32x32x16_bf16 v[80:95], v[64:67], v[48:51], v[80:95]
    v_mfma_f32_32x32x16_bf16 v[96:111], v[60:63], v[52:55], v[96:111]
    v_mfma_f32_32x32x16_bf16 v[80:95], v[68:71], v[52:55], v[80:95]
    ds_read_b128 v[48:51], v22 offset:12032
    ds_read_b128 v[56:59], v19 offset:2560
    ds_read_b128 v[52:55], v22 offset:12064
    ds_read_b128 v[60:63], v19 offset:2592
    ds_read_b128 v[64:67], v19 offset:0
    ds_read_b128 v[68:71], v19 offset:32
    s_waitcnt lgkmcnt(6)
    v_mfma_f32_32x32x16_bf16 v[96:111], v[32:35], v[24:27], v[96:111]
    v_mfma_f32_32x32x16_bf16 v[80:95], v[40:43], v[24:27], v[80:95]
    v_mfma_f32_32x32x16_bf16 v[96:111], v[36:39], v[28:31], v[96:111]
    v_mfma_f32_32x32x16_bf16 v[80:95], v[44:47], v[28:31], v[80:95]
    ds_read_b128 v[24:27], v22 offset:12288
    ds_read_b128 v[32:35], v19 offset:2240
    ds_read_b128 v[28:31], v22 offset:12320
    ds_read_b128 v[36:39], v19 offset:2272
    s_waitcnt lgkmcnt(4)
    v_mfma_f32_32x32x16_bf16 v[96:111], v[56:59], v[48:51], v[96:111]
    v_mfma_f32_32x32x16_bf16 v[80:95], v[64:67], v[48:51], v[80:95]
    v_mfma_f32_32x32x16_bf16 v[96:111], v[60:63], v[52:55], v[96:111]
    v_mfma_f32_32x32x16_bf16 v[80:95], v[68:71], v[52:55], v[80:95]
    ds_read_b128 v[48:51], v22 offset:12544
    ds_read_b128 v[56:59], v19 offset:1920
    ds_read_b128 v[52:55], v22 offset:12576
    ds_read_b128 v[60:63], v19 offset:1952
    s_waitcnt lgkmcnt(4)
    v_mfma_f32_32x32x16_bf16 v[96:111], v[32:35], v[24:27], v[96:111]
    v_mfma_f32_32x32x16_bf16 v[96:111], v[36:39], v[28:31], v[96:111]
    ds_read_b128 v[24:27], v22 offset:12800
    ds_read_b128 v[32:35], v19 offset:1600
    ds_read_b128 v[28:31], v22 offset:12832
    ds_read_b128 v[36:39], v19 offset:1632
    s_waitcnt lgkmcnt(4)
    v_mfma_f32_32x32x16_bf16 v[96:111], v[56:59], v[48:51], v[96:111]
    v_mfma_f32_32x32x16_bf16 v[96:111], v[60:63], v[52:55], v[96:111]
    ds_read_b128 v[48:51], v22 offset:13056
    ds_read_b128 v[56:59], v19 offset:1280
    ds_read_b128 v[52:55], v22 offset:13088
    ds_read_b128 v[60:63], v19 offset:1312
    s_waitcnt lgkmcnt(4)
    v_mfma_f32_32x32x16_bf16 v[96:111], v[32:35], v[24:27], v[96:111]
    v_mfma_f32_32x32x16_bf16 v[96:111], v[36:39], v[28:31], v[96:111]
    ds_read_b128 v[24:27], v22 offset:13312
    ds_read_b128 v[32:35], v19 offset:960
    ds_read_b128 v[28:31], v22 offset:13344
    ds_read_b128 v[36:39], v19 offset:992
    s_waitcnt lgkmcnt(4)
    v_mfma_f32_32x32x16_bf16 v[96:111], v[56:59], v[48:51], v[96:111]
    v_mfma_f32_32x32x16_bf16 v[96:111], v[60:63], v[52:55], v[96:111]
    ds_read_b128 v[48:51], v22 offset:13568
    ds_read_b128 v[56:59], v19 offset:640
    ds_read_b128 v[52:55], v22 offset:13600
    ds_read_b128 v[60:63], v19 offset:672
    s_waitcnt lgkmcnt(4)
    v_mfma_f32_32x32x16_bf16 v[96:111], v[32:35], v[24:27], v[96:111]
    v_mfma_f32_32x32x16_bf16 v[96:111], v[36:39], v[28:31], v[96:111]
    ds_read_b128 v[24:27], v22 offset:13824
    ds_read_b128 v[32:35], v19 offset:320
    ds_read_b128 v[28:31], v22 offset:13856
    ds_read_b128 v[36:39], v19 offset:352
    s_waitcnt lgkmcnt(4)
    v_mfma_f32_32x32x16_bf16 v[96:111], v[56:59], v[48:51], v[96:111]
    v_mfma_f32_32x32x16_bf16 v[96:111], v[60:63], v[52:55], v[96:111]
    ds_read_b128 v[48:51], v22 offset:14080
    ds_read_b128 v[56:59], v19 offset:0
    ds_read_b128 v[52:55], v22 offset:14112
    ds_read_b128 v[60:63], v19 offset:32
    s_waitcnt lgkmcnt(4)
    v_mfma_f32_32x32x16_bf16 v[96:111], v[32:35], v[24:27], v[96:111]
    v_mfma_f32_32x32x16_bf16 v[96:111], v[36:39], v[28:31], v[96:111]
    s_waitcnt lgkmcnt(0)
    v_mfma_f32_32x32x16_bf16 v[96:111], v[56:59], v[48:51], v[96:111]
    v_mfma_f32_32x32x16_bf16 v[96:111], v[60:63], v[52:55], v[96:111]
    s_nop 15
    s_nop 3
    s_barrier
    v_lshlrev_b32 v20, 7, v17
    v_add_u32 v20, v20, v16
    v_lshlrev_b32 v20, 2, v20
    v_lshlrev_b32 v21, 13, v18
    v_add_u32 v20, v20, v21
    ds_write_b32 v20, v80 offset:10240
    ds_write_b32 v20, v81 offset:10368
    ds_write_b32 v20, v82 offset:10496
    ds_write_b32 v20, v83 offset:10624
    ds_write_b32 v20, v84 offset:11264
    ds_write_b32 v20, v85 offset:11392
    ds_write_b32 v20, v86 offset:11520
    ds_write_b32 v20, v87 offset:11648
    ds_write_b32 v20, v88 offset:12288
    ds_write_b32 v20, v89 offset:12416
    ds_write_b32 v20, v90 offset:12544
    ds_write_b32 v20, v91 offset:12672
    ds_write_b32 v20, v92 offset:13312
    ds_write_b32 v20, v93 offset:13440
    ds_write_b32 v20, v94 offset:13568
    ds_write_b32 v20, v95 offset:13696
    ds_write_b32 v20, v96 offset:14336
    ds_write_b32 v20, v97 offset:14464
    ds_write_b32 v20, v98 offset:14592
    ds_write_b32 v20, v99 offset:14720
    ds_write_b32 v20, v100 offset:15360
    ds_write_b32 v20, v101 offset:15488
    ds_write_b32 v20, v102 offset:15616
    ds_write_b32 v20, v103 offset:15744
    ds_write_b32 v20, v104 offset:16384
    ds_write_b32 v20, v105 offset:16512
    ds_write_b32 v20, v106 offset:16640
    ds_write_b32 v20, v107 offset:16768
    ds_write_b32 v20, v108 offset:17408
    ds_write_b32 v20, v109 offset:17536
    ds_write_b32 v20, v110 offset:17664
    ds_write_b32 v20, v111 offset:17792
    s_waitcnt lgkmcnt(0)
    s_barrier
    v_lshlrev_b32 v20, 5, v0
    ds_read_b128 v[24:27], v20 offset:10240
    ds_read_b128 v[28:31], v20 offset:10256
    ds_read_b128 v[32:35], v20 offset:18432
    ds_read_b128 v[36:39], v20 offset:18448
    ds_read_b128 v[40:43], v20 offset:26624
    ds_read_b128 v[44:47], v20 offset:26640
    ds_read_b128 v[48:51], v20 offset:34816
    ds_read_b128 v[52:55], v20 offset:34832
    s_waitcnt lgkmcnt(0)
    v_add_f32 v24, v24, v32
    v_add_f32 v25, v25, v33
    v_add_f32 v26, v26, v34
    v_add_f32 v27, v27, v35
    v_add_f32 v28, v28, v36
    v_add_f32 v29, v29, v37
    v_add_f32 v30, v30, v38
    v_add_f32 v31, v31, v39
    v_add_f32 v24, v24, v40
    v_add_f32 v25, v25, v41
    v_add_f32 v26, v26, v42
    v_add_f32 v27, v27, v43
    v_add_f32 v28, v28, v44
    v_add_f32 v29, v29, v45
    v_add_f32 v30, v30, v46
    v_add_f32 v31, v31, v47
    v_add_f32 v24, v24, v48
    v_add_f32 v25, v25, v49
    v_add_f32 v26, v26, v50
    v_add_f32 v27, v27, v51
    v_add_f32 v28, v28, v52
    v_add_f32 v29, v29, v53
    v_add_f32 v30, v30, v54
    v_add_f32 v31, v31, v55
    v_lshlrev_b32 v3, 16, v3
    s_waitcnt lgkmcnt(0)
    v_lshlrev_b32 v33, 16, v4
    v_mul_f32 v33, v33, v3
    v_cvt_pk_bf16_f32 v34, v33, v33
    v_lshlrev_b32 v33, 16, v34
    v_cvt_pk_bf16_f32 v34, v24, v24
    v_lshlrev_b32 v24, 16, v34
    v_add_f32 v24, v24, v33
    v_and_b32 v33, 0xffff0000, v4
    v_mul_f32 v33, v33, v3
    v_cvt_pk_bf16_f32 v34, v33, v33
    v_lshlrev_b32 v33, 16, v34
    v_cvt_pk_bf16_f32 v34, v25, v25
    v_lshlrev_b32 v25, 16, v34
    v_add_f32 v25, v25, v33
    v_lshlrev_b32 v33, 16, v5
    v_mul_f32 v33, v33, v3
    v_cvt_pk_bf16_f32 v34, v33, v33
    v_lshlrev_b32 v33, 16, v34
    v_cvt_pk_bf16_f32 v34, v26, v26
    v_lshlrev_b32 v26, 16, v34
    v_add_f32 v26, v26, v33
    v_and_b32 v33, 0xffff0000, v5
    v_mul_f32 v33, v33, v3
    v_cvt_pk_bf16_f32 v34, v33, v33
    v_lshlrev_b32 v33, 16, v34
    v_cvt_pk_bf16_f32 v34, v27, v27
    v_lshlrev_b32 v27, 16, v34
    v_add_f32 v27, v27, v33
    v_lshlrev_b32 v33, 16, v6
    v_mul_f32 v33, v33, v3
    v_cvt_pk_bf16_f32 v34, v33, v33
    v_lshlrev_b32 v33, 16, v34
    v_cvt_pk_bf16_f32 v34, v28, v28
    v_lshlrev_b32 v28, 16, v34
    v_add_f32 v28, v28, v33
    v_and_b32 v33, 0xffff0000, v6
    v_mul_f32 v33, v33, v3
    v_cvt_pk_bf16_f32 v34, v33, v33
    v_lshlrev_b32 v33, 16, v34
    v_cvt_pk_bf16_f32 v34, v29, v29
    v_lshlrev_b32 v29, 16, v34
    v_add_f32 v29, v29, v33
    v_lshlrev_b32 v33, 16, v7
    v_mul_f32 v33, v33, v3
    v_cvt_pk_bf16_f32 v34, v33, v33
    v_lshlrev_b32 v33, 16, v34
    v_cvt_pk_bf16_f32 v34, v30, v30
    v_lshlrev_b32 v30, 16, v34
    v_add_f32 v30, v30, v33
    v_and_b32 v33, 0xffff0000, v7
    v_mul_f32 v33, v33, v3
    v_cvt_pk_bf16_f32 v34, v33, v33
    v_lshlrev_b32 v33, 16, v34
    v_cvt_pk_bf16_f32 v34, v31, v31
    v_lshlrev_b32 v31, 16, v34
    v_add_f32 v31, v31, v33
    v_cvt_pk_bf16_f32 v36, v24, v25
    v_cvt_pk_bf16_f32 v37, v26, v27
    v_cvt_pk_bf16_f32 v38, v28, v29
    v_cvt_pk_bf16_f32 v39, v30, v31
    buffer_store_dwordx4 v[36:39], v1, s[20:23], s4 offen
conv_kernel_end:
    s_endpgm
.globl hln_kernel
.p2align 8
.type hln_kernel,@function
hln_kernel:
    s_cmp_ge_u32 s2, 128
    s_cbranch_scc1 hln_kernel_end
    s_load_dwordx16 s[64:79], s[0:1], 0
    s_load_dwordx8 s[80:87], s[0:1], 64
    s_load_dwordx4 s[88:91], s[0:1], 96
    s_waitcnt lgkmcnt(0)
    s_add_u32 s8, s90, 2097152
    s_addc_u32 s9, s91, 0
    s_mov_b32 s10, 1835008
    s_mov_b32 s11, 0x00020000
    s_add_u32 s12, s64, 0
    s_addc_u32 s13, s65, 0
    s_mov_b32 s14, 1835008
    s_mov_b32 s15, 0x00020000
    s_add_u32 s16, s90, 4194304
    s_addc_u32 s17, s91, 0
    s_mov_b32 s18, 1835008
    s_mov_b32 s19, 0x00020000
    s_add_u32 s20, s90, 6291456
    s_addc_u32 s21, s91, 0
    s_mov_b32 s22, 1835008
    s_mov_b32 s23, 0x00020000
    s_lshl_b32 s4, s2, 5
    v_lshrrev_b32 v3, 1, v0
    v_and_b32 v2, 1, v0
    v_lshlrev_b32 v4, 12, v3
    v_lshlrev_b32 v5, 4, v2
    v_add_u32 v4, v4, v5
    v_cmp_gt_u32 vcc, 448, v3
    s_and_saveexec_b64 s[24:25], vcc
    s_cbranch_execz hln_skip
    buffer_load_dwordx4 v[8:11], v4, s[8:11], s4 offen
    v_lshlrev_b32 v4, 1, v3
    v_mul_u32_u24 v5, 7296, v2
    v_add_u32 v4, v4, v5
    s_waitcnt vmcnt(0)
    ds_write_b16 v4, v8 offset:0
    v_lshrrev_b32 v12, 16, v8
    ds_write_b16 v4, v12 offset:912
    ds_write_b16 v4, v9 offset:1824
    v_lshrrev_b32 v12, 16, v9
    ds_write_b16 v4, v12 offset:2736
    ds_write_b16 v4, v10 offset:3648
    v_lshrrev_b32 v12, 16, v10
    ds_write_b16 v4, v12 offset:4560
    ds_write_b16 v4, v11 offset:5472
    v_lshrrev_b32 v12, 16, v11
    ds_write_b16 v4, v12 offset:6384
hln_skip:
    s_mov_b64 exec, s[24:25]
    v_and_b32 v1, 63, v0
    v_lshrrev_b32 v3, 6, v0
    s_lshl_b32 s5, s2, 4
    v_add_u32 v4, s5, v3
    v_mul_u32_u24 v4, 896, v4
    v_lshlrev_b32 v5, 1, v1
    v_add_u32 v4, v4, v5
    v_mul_u32_u24 v6, 912, v3
    v_add_u32 v6, v6, v5
    buffer_load_ushort v10, v4, s[12:15], 0 offen offset:0
    buffer_load_ushort v11, v4, s[12:15], 0 offen offset:128
    buffer_load_ushort v12, v4, s[12:15], 0 offen offset:256
    buffer_load_ushort v13, v4, s[12:15], 0 offen offset:384
    buffer_load_ushort v14, v4, s[12:15], 0 offen offset:512
    buffer_load_ushort v15, v4, s[12:15], 0 offen offset:640
    buffer_load_ushort v16, v4, s[12:15], 0 offen offset:768
    s_waitcnt lgkmcnt(0)
    s_barrier
    ds_read_u16 v20, v6 offset:0
    ds_read_u16 v21, v6 offset:128
    ds_read_u16 v22, v6 offset:256
    ds_read_u16 v23, v6 offset:384
    ds_read_u16 v24, v6 offset:512
    ds_read_u16 v25, v6 offset:640
    ds_read_u16 v26, v6 offset:768
    s_waitcnt vmcnt(0) lgkmcnt(0)
    v_lshlrev_b32 v10, 16, v10
    v_lshlrev_b32 v20, 16, v20
    v_mov_b32 v30, v10
    v_lshlrev_b32 v11, 16, v11
    v_lshlrev_b32 v21, 16, v21
    v_mov_b32 v31, v11
    v_lshlrev_b32 v12, 16, v12
    v_lshlrev_b32 v22, 16, v22
    v_mov_b32 v32, v12
    v_lshlrev_b32 v13, 16, v13
    v_lshlrev_b32 v23, 16, v23
    v_mov_b32 v33, v13
    v_lshlrev_b32 v14, 16, v14
    v_lshlrev_b32 v24, 16, v24
    v_mov_b32 v34, v14
    v_lshlrev_b32 v15, 16, v15
    v_lshlrev_b32 v25, 16, v25
    v_mov_b32 v35, v15
    v_lshlrev_b32 v16, 16, v16
    v_lshlrev_b32 v26, 16, v26
    v_mov_b32 v36, v16
    v_mov_b32 v40, v30
    v_add_f32 v40, v40, v31
    v_add_f32 v40, v40, v32
    v_add_f32 v40, v40, v33
    v_add_f32 v40, v40, v34
    v_add_f32 v40, v40, v35
    v_add_f32 v40, v40, v36
    ds_swizzle_b32 v43, v40 offset:0x41f
    s_waitcnt lgkmcnt(0)
    v_add_f32 v40, v40, v43
    ds_swizzle_b32 v43, v40 offset:0x81f
    s_waitcnt lgkmcnt(0)
    v_add_f32 v40, v40, v43
    ds_swizzle_b32 v43, v40 offset:0x101f
    s_waitcnt lgkmcnt(0)
    v_add_f32 v40, v40, v43
    ds_swizzle_b32 v43, v40 offset:0x201f
    s_waitcnt lgkmcnt(0)
    v_add_f32 v40, v40, v43
    ds_swizzle_b32 v43, v40 offset:0x401f
    s_waitcnt lgkmcnt(0)
    v_add_f32 v40, v40, v43
    s_nop 1
    v_readlane_b32 s98, v40, 0
    v_readlane_b32 s99, v40, 32
    s_nop 3
    v_mov_b32 v40, s98
    v_add_f32 v40, s99, v40
    v_mul_f32 v41, 0x3b124925, v40
    v_mov_b32 v40, 0
    v_sub_f32 v42, v30, v41
    v_fmac_f32 v40, v42, v42
    v_sub_f32 v42, v31, v41
    v_fmac_f32 v40, v42, v42
    v_sub_f32 v42, v32, v41
    v_fmac_f32 v40, v42, v42
    v_sub_f32 v42, v33, v41
    v_fmac_f32 v40, v42, v42
    v_sub_f32 v42, v34, v41
    v_fmac_f32 v40, v42, v42
    v_sub_f32 v42, v35, v41
    v_fmac_f32 v40, v42, v42
    v_sub_f32 v42, v36, v41
    v_fmac_f32 v40, v42, v42
    ds_swizzle_b32 v43, v40 offset:0x41f
    s_waitcnt lgkmcnt(0)
    v_add_f32 v40, v40, v43
    ds_swizzle_b32 v43, v40 offset:0x81f
    s_waitcnt lgkmcnt(0)
    v_add_f32 v40, v40, v43
    ds_swizzle_b32 v43, v40 offset:0x101f
    s_waitcnt lgkmcnt(0)
    v_add_f32 v40, v40, v43
    ds_swizzle_b32 v43, v40 offset:0x201f
    s_waitcnt lgkmcnt(0)
    v_add_f32 v40, v40, v43
    ds_swizzle_b32 v43, v40 offset:0x401f
    s_waitcnt lgkmcnt(0)
    v_add_f32 v40, v40, v43
    s_nop 1
    v_readlane_b32 s98, v40, 0
    v_readlane_b32 s99, v40, 32
    s_nop 3
    v_mov_b32 v40, s98
    v_add_f32 v40, s99, v40
    v_mul_f32 v40, 0x3b124925, v40
    v_cvt_pk_bf16_f32 v43, v40, v40
    v_lshlrev_b32 v40, 16, v43
    v_cvt_pk_bf16_f32 v43, v41, v41
    v_lshlrev_b32 v41, 16, v43
    v_add_f32 v40, 0x3727c5ac, v40
    v_cvt_pk_bf16_f32 v43, v40, v40
    v_lshlrev_b32 v40, 16, v43
    v_sqrt_f32 v40, v40
    s_nop 0
    v_cvt_pk_bf16_f32 v43, v40, v40
    v_lshlrev_b32 v40, 16, v43
    v_rcp_f32 v42, v40
    s_nop 0
    v_fma_f32 v43, -v40, v42, 1.0
    v_fmac_f32 v42, v43, v42
    v_sub_f32 v30, v30, v41
    v_cvt_pk_bf16_f32 v43, v30, v30
    v_lshlrev_b32 v30, 16, v43
    v_mul_f32 v30, v30, v42
    v_cvt_pk_bf16_f32 v43, v30, v30
    v_lshlrev_b32 v30, 16, v43
    v_sub_f32 v31, v31, v41
    v_cvt_pk_bf16_f32 v43, v31, v31
    v_lshlrev_b32 v31, 16, v43
    v_mul_f32 v31, v31, v42
    v_cvt_pk_bf16_f32 v43, v31, v31
    v_lshlrev_b32 v31, 16, v43
    v_sub_f32 v32, v32, v41
    v_cvt_pk_bf16_f32 v43, v32, v32
    v_lshlrev_b32 v32, 16, v43
    v_mul_f32 v32, v32, v42
    v_cvt_pk_bf16_f32 v43, v32, v32
    v_lshlrev_b32 v32, 16, v43
    v_sub_f32 v33, v33, v41
    v_cvt_pk_bf16_f32 v43, v33, v33
    v_lshlrev_b32 v33, 16, v43
    v_mul_f32 v33, v33, v42
    v_cvt_pk_bf16_f32 v43, v33, v33
    v_lshlrev_b32 v33, 16, v43
    v_sub_f32 v34, v34, v41
    v_cvt_pk_bf16_f32 v43, v34, v34
    v_lshlrev_b32 v34, 16, v43
    v_mul_f32 v34, v34, v42
    v_cvt_pk_bf16_f32 v43, v34, v34
    v_lshlrev_b32 v34, 16, v43
    v_sub_f32 v35, v35, v41
    v_cvt_pk_bf16_f32 v43, v35, v35
    v_lshlrev_b32 v35, 16, v43
    v_mul_f32 v35, v35, v42
    v_cvt_pk_bf16_f32 v43, v35, v35
    v_lshlrev_b32 v35, 16, v43
    v_sub_f32 v36, v36, v41
    v_cvt_pk_bf16_f32 v43, v36, v36
    v_lshlrev_b32 v36, 16, v43
    v_mul_f32 v36, v36, v42
    v_cvt_pk_bf16_f32 v43, v36, v36
    v_lshlrev_b32 v36, 16, v43
    v_mul_f32 v30, v30, v20
    v_cvt_pk_bf16_f32 v44, v30, v30
    v_lshlrev_b32 v30, 16, v44
    v_add_f32 v30, v30, v10
    v_cvt_pk_bf16_f32 v44, v30, v30
    v_lshlrev_b32 v30, 16, v44
    v_lshrrev_b32 v45, 16, v30
    buffer_store_short v45, v4, s[16:19], 0 offen offset:0
    v_mul_f32 v31, v31, v21
    v_cvt_pk_bf16_f32 v44, v31, v31
    v_lshlrev_b32 v31, 16, v44
    v_add_f32 v31, v31, v11
    v_cvt_pk_bf16_f32 v44, v31, v31
    v_lshlrev_b32 v31, 16, v44
    v_lshrrev_b32 v45, 16, v31
    buffer_store_short v45, v4, s[16:19], 0 offen offset:128
    v_mul_f32 v32, v32, v22
    v_cvt_pk_bf16_f32 v44, v32, v32
    v_lshlrev_b32 v32, 16, v44
    v_add_f32 v32, v32, v12
    v_cvt_pk_bf16_f32 v44, v32, v32
    v_lshlrev_b32 v32, 16, v44
    v_lshrrev_b32 v45, 16, v32
    buffer_store_short v45, v4, s[16:19], 0 offen offset:256
    v_mul_f32 v33, v33, v23
    v_cvt_pk_bf16_f32 v44, v33, v33
    v_lshlrev_b32 v33, 16, v44
    v_add_f32 v33, v33, v13
    v_cvt_pk_bf16_f32 v44, v33, v33
    v_lshlrev_b32 v33, 16, v44
    v_lshrrev_b32 v45, 16, v33
    buffer_store_short v45, v4, s[16:19], 0 offen offset:384
    v_mul_f32 v34, v34, v24
    v_cvt_pk_bf16_f32 v44, v34, v34
    v_lshlrev_b32 v34, 16, v44
    v_add_f32 v34, v34, v14
    v_cvt_pk_bf16_f32 v44, v34, v34
    v_lshlrev_b32 v34, 16, v44
    v_lshrrev_b32 v45, 16, v34
    buffer_store_short v45, v4, s[16:19], 0 offen offset:512
    v_mul_f32 v35, v35, v25
    v_cvt_pk_bf16_f32 v44, v35, v35
    v_lshlrev_b32 v35, 16, v44
    v_add_f32 v35, v35, v15
    v_cvt_pk_bf16_f32 v44, v35, v35
    v_lshlrev_b32 v35, 16, v44
    v_lshrrev_b32 v45, 16, v35
    buffer_store_short v45, v4, s[16:19], 0 offen offset:640
    v_mul_f32 v36, v36, v26
    v_cvt_pk_bf16_f32 v44, v36, v36
    v_lshlrev_b32 v36, 16, v44
    v_add_f32 v36, v36, v16
    v_cvt_pk_bf16_f32 v44, v36, v36
    v_lshlrev_b32 v36, 16, v44
    v_lshrrev_b32 v45, 16, v36
    buffer_store_short v45, v4, s[16:19], 0 offen offset:768
    v_mov_b32 v40, v30
    v_add_f32 v40, v40, v31
    v_add_f32 v40, v40, v32
    v_add_f32 v40, v40, v33
    v_add_f32 v40, v40, v34
    v_add_f32 v40, v40, v35
    v_add_f32 v40, v40, v36
    ds_swizzle_b32 v43, v40 offset:0x41f
    s_waitcnt lgkmcnt(0)
    v_add_f32 v40, v40, v43
    ds_swizzle_b32 v43, v40 offset:0x81f
    s_waitcnt lgkmcnt(0)
    v_add_f32 v40, v40, v43
    ds_swizzle_b32 v43, v40 offset:0x101f
    s_waitcnt lgkmcnt(0)
    v_add_f32 v40, v40, v43
    ds_swizzle_b32 v43, v40 offset:0x201f
    s_waitcnt lgkmcnt(0)
    v_add_f32 v40, v40, v43
    ds_swizzle_b32 v43, v40 offset:0x401f
    s_waitcnt lgkmcnt(0)
    v_add_f32 v40, v40, v43
    s_nop 1
    v_readlane_b32 s98, v40, 0
    v_readlane_b32 s99, v40, 32
    s_nop 3
    v_mov_b32 v40, s98
    v_add_f32 v40, s99, v40
    v_mul_f32 v41, 0x3b124925, v40
    v_mov_b32 v40, 0
    v_sub_f32 v42, v30, v41
    v_fmac_f32 v40, v42, v42
    v_sub_f32 v42, v31, v41
    v_fmac_f32 v40, v42, v42
    v_sub_f32 v42, v32, v41
    v_fmac_f32 v40, v42, v42
    v_sub_f32 v42, v33, v41
    v_fmac_f32 v40, v42, v42
    v_sub_f32 v42, v34, v41
    v_fmac_f32 v40, v42, v42
    v_sub_f32 v42, v35, v41
    v_fmac_f32 v40, v42, v42
    v_sub_f32 v42, v36, v41
    v_fmac_f32 v40, v42, v42
    ds_swizzle_b32 v43, v40 offset:0x41f
    s_waitcnt lgkmcnt(0)
    v_add_f32 v40, v40, v43
    ds_swizzle_b32 v43, v40 offset:0x81f
    s_waitcnt lgkmcnt(0)
    v_add_f32 v40, v40, v43
    ds_swizzle_b32 v43, v40 offset:0x101f
    s_waitcnt lgkmcnt(0)
    v_add_f32 v40, v40, v43
    ds_swizzle_b32 v43, v40 offset:0x201f
    s_waitcnt lgkmcnt(0)
    v_add_f32 v40, v40, v43
    ds_swizzle_b32 v43, v40 offset:0x401f
    s_waitcnt lgkmcnt(0)
    v_add_f32 v40, v40, v43
    s_nop 1
    v_readlane_b32 s98, v40, 0
    v_readlane_b32 s99, v40, 32
    s_nop 3
    v_mov_b32 v40, s98
    v_add_f32 v40, s99, v40
    v_mul_f32 v40, 0x3b124925, v40
    v_cvt_pk_bf16_f32 v43, v40, v40
    v_lshlrev_b32 v40, 16, v43
    v_cvt_pk_bf16_f32 v43, v41, v41
    v_lshlrev_b32 v41, 16, v43
    v_add_f32 v40, 0x3727c5ac, v40
    v_cvt_pk_bf16_f32 v43, v40, v40
    v_lshlrev_b32 v40, 16, v43
    v_sqrt_f32 v40, v40
    s_nop 0
    v_cvt_pk_bf16_f32 v43, v40, v40
    v_lshlrev_b32 v40, 16, v43
    v_rcp_f32 v42, v40
    s_nop 0
    v_fma_f32 v43, -v40, v42, 1.0
    v_fmac_f32 v42, v43, v42
    v_sub_f32 v30, v30, v41
    v_cvt_pk_bf16_f32 v43, v30, v30
    v_lshlrev_b32 v30, 16, v43
    v_mul_f32 v30, v30, v42
    v_cvt_pk_bf16_f32 v43, v30, v30
    v_lshlrev_b32 v30, 16, v43
    v_sub_f32 v31, v31, v41
    v_cvt_pk_bf16_f32 v43, v31, v31
    v_lshlrev_b32 v31, 16, v43
    v_mul_f32 v31, v31, v42
    v_cvt_pk_bf16_f32 v43, v31, v31
    v_lshlrev_b32 v31, 16, v43
    v_sub_f32 v32, v32, v41
    v_cvt_pk_bf16_f32 v43, v32, v32
    v_lshlrev_b32 v32, 16, v43
    v_mul_f32 v32, v32, v42
    v_cvt_pk_bf16_f32 v43, v32, v32
    v_lshlrev_b32 v32, 16, v43
    v_sub_f32 v33, v33, v41
    v_cvt_pk_bf16_f32 v43, v33, v33
    v_lshlrev_b32 v33, 16, v43
    v_mul_f32 v33, v33, v42
    v_cvt_pk_bf16_f32 v43, v33, v33
    v_lshlrev_b32 v33, 16, v43
    v_sub_f32 v34, v34, v41
    v_cvt_pk_bf16_f32 v43, v34, v34
    v_lshlrev_b32 v34, 16, v43
    v_mul_f32 v34, v34, v42
    v_cvt_pk_bf16_f32 v43, v34, v34
    v_lshlrev_b32 v34, 16, v43
    v_sub_f32 v35, v35, v41
    v_cvt_pk_bf16_f32 v43, v35, v35
    v_lshlrev_b32 v35, 16, v43
    v_mul_f32 v35, v35, v42
    v_cvt_pk_bf16_f32 v43, v35, v35
    v_lshlrev_b32 v35, 16, v43
    v_sub_f32 v36, v36, v41
    v_cvt_pk_bf16_f32 v43, v36, v36
    v_lshlrev_b32 v36, 16, v43
    v_mul_f32 v36, v36, v42
    v_cvt_pk_bf16_f32 v43, v36, v36
    v_lshlrev_b32 v36, 16, v43
    v_lshrrev_b32 v45, 16, v30
    buffer_store_short v45, v4, s[20:23], 0 offen offset:0
    v_lshrrev_b32 v45, 16, v31
    buffer_store_short v45, v4, s[20:23], 0 offen offset:128
    v_lshrrev_b32 v45, 16, v32
    buffer_store_short v45, v4, s[20:23], 0 offen offset:256
    v_lshrrev_b32 v45, 16, v33
    buffer_store_short v45, v4, s[20:23], 0 offen offset:384
    v_lshrrev_b32 v45, 16, v34
    buffer_store_short v45, v4, s[20:23], 0 offen offset:512
    v_lshrrev_b32 v45, 16, v35
    buffer_store_short v45, v4, s[20:23], 0 offen offset:640
    v_lshrrev_b32 v45, 16, v36
    buffer_store_short v45, v4, s[20:23], 0 offen offset:768
hln_kernel_end:
    s_endpgm
.globl gemm1_kernel
.p2align 8
.type gemm1_kernel,@function
gemm1_kernel:
    s_cmp_ge_u32 s2, 448
    s_cbranch_scc1 gemm1_kernel_end
    s_load_dwordx16 s[64:79], s[0:1], 0
    s_load_dwordx8 s[80:87], s[0:1], 64
    s_load_dwordx4 s[88:91], s[0:1], 96
    s_waitcnt lgkmcnt(0)
    s_add_u32 s8, s90, 8388608
    s_addc_u32 s9, s91, 0
    s_mov_b32 s10, 1605632
    s_mov_b32 s11, 0x00020000
    s_add_u32 s12, s90, 6291456
    s_addc_u32 s13, s91, 0
    s_mov_b32 s14, 1835008
    s_mov_b32 s15, 0x00020000
    s_mul_i32 s5, s2, 4682
    s_lshr_b32 s5, s5, 16
    s_mul_i32 s4, s5, 14
    s_sub_u32 s4, s2, s4
    s_lshl_b32 s4, s4, 7
    s_lshl_b32 s5, s5, 6
    s_mov_b32 s26, 896
    s_mov_b32 s27, 896
    v_lshrrev_b32 v15, 6, v0
    v_and_b32 v1, 63, v0
    v_lshrrev_b32 v2, 3, v1
    v_and_b32 v3, 7, v1
    s_nop 0
    v_readfirstlane_b32 s28, v15
    s_nop 3
    s_lshl_b32 s28, s28, 10
    v_lshlrev_b32 v20, 3, v15
    v_add_u32 v20, 0, v20
    v_add_u32 v20, v20, v2
    v_bfe_u32 v21, v20, 1, 3
    v_xor_b32 v21, v21, v3
    v_lshlrev_b32 v21, 4, v21
    v_add_u32 v20, s4, v20
    v_mul_lo_u32 v20, v20, s26
    v_add_u32 v24, v20, v21
    v_lshlrev_b32 v20, 3, v15
    v_add_u32 v20, 32, v20
    v_add_u32 v20, v20, v2
    v_bfe_u32 v21, v20, 1, 3
    v_xor_b32 v21, v21, v3
    v_lshlrev_b32 v21, 4, v21
    v_add_u32 v20, s4, v20
    v_mul_lo_u32 v20, v20, s26
    v_add_u32 v25, v20, v21
    v_lshlrev_b32 v20, 3, v15
    v_add_u32 v20, 64, v20
    v_add_u32 v20, v20, v2
    v_bfe_u32 v21, v20, 1, 3
    v_xor_b32 v21, v21, v3
    v_lshlrev_b32 v21, 4, v21
    v_add_u32 v20, s4, v20
    v_mul_lo_u32 v20, v20, s26
    v_add_u32 v26, v20, v21
    v_lshlrev_b32 v20, 3, v15
    v_add_u32 v20, 96, v20
    v_add_u32 v20, v20, v2
    v_bfe_u32 v21, v20, 1, 3
    v_xor_b32 v21, v21, v3
    v_lshlrev_b32 v21, 4, v21
    v_add_u32 v20, s4, v20
    v_mul_lo_u32 v20, v20, s26
    v_add_u32 v27, v20, v21
    v_lshlrev_b32 v20, 3, v15
    v_add_u32 v20, 0, v20
    v_add_u32 v20, v20, v2
    v_bfe_u32 v21, v20, 1, 3
    v_xor_b32 v21, v21, v3
    v_lshlrev_b32 v21, 4, v21
    v_add_u32 v20, s5, v20
    v_mul_lo_u32 v20, v20, s27
    v_add_u32 v28, v20, v21
    v_lshlrev_b32 v20, 3, v15
    v_add_u32 v20, 32, v20
    v_add_u32 v20, v20, v2
    v_bfe_u32 v21, v20, 1, 3
    v_xor_b32 v21, v21, v3
    v_lshlrev_b32 v21, 4, v21
    v_add_u32 v20, s5, v20
    v_mul_lo_u32 v20, v20, s27
    v_add_u32 v29, v20, v21
    v_and_b32 v13, 31, v0
    v_bfe_u32 v14, v0, 5, 1
    v_and_b32 v16, 1, v15
    v_lshrrev_b32 v17, 1, v15
    v_mul_u32_u24 v16, 64, v16
    v_mul_u32_u24 v17, 32, v17
    v_add_u32 v20, v16, v13
    v_bfe_u32 v21, v20, 1, 3
    v_and_b32 v22, 1, v21
    v_xor_b32 v22, v22, v14
    v_lshlrev_b32 v22, 4, v22
    v_lshlrev_b32 v20, 7, v20
    v_add_u32 v20, v20, v22
    v_add_u32 v20, 0, v20
    v_lshrrev_b32 v21, 1, v21
    v_xor_b32 v22, 0, v21
    v_lshlrev_b32 v22, 5, v22
    v_add_u32 v40, v20, v22
    v_xor_b32 v22, 1, v21
    v_lshlrev_b32 v22, 5, v22
    v_add_u32 v41, v20, v22
    v_xor_b32 v22, 2, v21
    v_lshlrev_b32 v22, 5, v22
    v_add_u32 v42, v20, v22
    v_xor_b32 v22, 3, v21
    v_lshlrev_b32 v22, 5, v22
    v_add_u32 v43, v20, v22
    v_add_u32 v20, v17, v13
    v_bfe_u32 v21, v20, 1, 3
    v_and_b32 v22, 1, v21
    v_xor_b32 v22, v22, v14
    v_lshlrev_b32 v22, 4, v22
    v_lshlrev_b32 v20, 7, v20
    v_add_u32 v20, v20, v22
    v_add_u32 v20, 16384, v20
    v_lshrrev_b32 v21, 1, v21
    v_xor_b32 v22, 0, v21
    v_lshlrev_b32 v22, 5, v22
    v_add_u32 v44, v20, v22
    v_xor_b32 v22, 1, v21
    v_lshlrev_b32 v22, 5, v22
    v_add_u32 v45, v20, v22
    v_xor_b32 v22, 2, v21
    v_lshlrev_b32 v22, 5, v22
    v_add_u32 v46, v20, v22
    v_xor_b32 v22, 3, v21
    v_lshlrev_b32 v22, 5, v22
    v_add_u32 v47, v20, v22
    v_mov_b32 v96, 0
    v_mov_b32 v97, 0
    v_mov_b32 v98, 0
    v_mov_b32 v99, 0
    v_mov_b32 v100, 0
    v_mov_b32 v101, 0
    v_mov_b32 v102, 0
    v_mov_b32 v103, 0
    v_mov_b32 v104, 0
    v_mov_b32 v105, 0
    v_mov_b32 v106, 0
    v_mov_b32 v107, 0
    v_mov_b32 v108, 0
    v_mov_b32 v109, 0
    v_mov_b32 v110, 0
    v_mov_b32 v111, 0
    v_mov_b32 v112, 0
    v_mov_b32 v113, 0
    v_mov_b32 v114, 0
    v_mov_b32 v115, 0
    v_mov_b32 v116, 0
    v_mov_b32 v117, 0
    v_mov_b32 v118, 0
    v_mov_b32 v119, 0
    v_mov_b32 v120, 0
    v_mov_b32 v121, 0
    v_mov_b32 v122, 0
    v_mov_b32 v123, 0
    v_mov_b32 v124, 0
    v_mov_b32 v125, 0
    v_mov_b32 v126, 0
    v_mov_b32 v127, 0
    s_mul_i32 s6, s2, 5
    s_lshr_b32 s33, s2, 3
    s_add_u32 s6, s6, s33
    s_mul_hi_u32 s33, s6, 613566757
    s_mul_i32 s33, s33, 7
    s_sub_u32 s6, s6, s33
    s_lshl_b32 s6, s6, 7
    s_mov_b32 s29, s28
    s_add_u32 s30, s28, 73728
    s_mov_b32 s31, 0
    s_mov_b32 s34, 4294918144
    s_mov_b32 s35, 24576
    s_add_u32 m0, s29, 0
    s_nop 0
    buffer_load_dwordx4 v24, s[8:11], s6 offen lds
    s_add_u32 m0, s29, 4096
    s_nop 0
    buffer_load_dwordx4 v25, s[8:11], s6 offen lds
    s_add_u32 m0, s29, 8192
    s_nop 0
    buffer_load_dwordx4 v26, s[8:11], s6 offen lds
    s_add_u32 m0, s29, 12288
    s_nop 0
    buffer_load_dwordx4 v27, s[8:11], s6 offen lds
    s_add_u32 m0, s29, 16384
    s_nop 0
    buffer_load_dwordx4 v28, s[12:15], s6 offen lds
    s_add_u32 m0, s29, 20480
    s_nop 0
    buffer_load_dwordx4 v29, s[12:15], s6 offen lds
    s_add_u32 s6, s6, 128
    s_cmp_ge_u32 s6, 896
    s_cselect_b32 s6, 0, s6
    s_add_u32 s29, s29, 24576
    s_cmp_ge_u32 s29, s30
    s_cselect_b32 s29, s28, s29
    s_add_u32 m0, s29, 0
    s_nop 0
    buffer_load_dwordx4 v24, s[8:11], s6 offen lds
    s_add_u32 m0, s29, 4096
    s_nop 0
    buffer_load_dwordx4 v25, s[8:11], s6 offen lds
    s_add_u32 m0, s29, 8192
    s_nop 0
    buffer_load_dwordx4 v26, s[8:11], s6 offen lds
    s_add_u32 m0, s29, 12288
    s_nop 0
    buffer_load_dwordx4 v27, s[8:11], s6 offen lds
    s_add_u32 m0, s29, 16384
    s_nop 0
    buffer_load_dwordx4 v28, s[12:15], s6 offen lds
    s_add_u32 m0, s29, 20480
    s_nop 0
    buffer_load_dwordx4 v29, s[12:15], s6 offen lds
    s_add_u32 s6, s6, 128
    s_cmp_ge_u32 s6, 896
    s_cselect_b32 s6, 0, s6
    s_add_u32 s29, s29, 24576
    s_cmp_ge_u32 s29, s30
    s_cselect_b32 s29, s28, s29
    s_waitcnt vmcnt(6)
    s_barrier
    s_mov_b32 s7, 0
gemm1_kernel_loop:
    ds_read_b128 v[48:51], v40 offset:0
    ds_read_b128 v[56:59], v40 offset:4096
    ds_read_b128 v[64:67], v44 offset:0
    ds_read_b128 v[52:55], v41 offset:0
    ds_read_b128 v[60:63], v41 offset:4096
    ds_read_b128 v[68:71], v45 offset:0
    s_waitcnt lgkmcnt(3)
    v_mfma_f32_32x32x16_bf16 v[96:111], v[48:51], v[64:67], v[96:111]
    s_add_u32 m0, s29, 0
    s_nop 0
    buffer_load_dwordx4 v24, s[8:11], s6 offen lds
    v_mfma_f32_32x32x16_bf16 v[112:127], v[56:59], v[64:67], v[112:127]
    s_add_u32 m0, s29, 4096
    s_nop 0
    buffer_load_dwordx4 v25, s[8:11], s6 offen lds
    ds_read_b128 v[48:51], v42 offset:0
    ds_read_b128 v[56:59], v42 offset:4096
    ds_read_b128 v[64:67], v46 offset:0
    s_waitcnt lgkmcnt(3)
    v_mfma_f32_32x32x16_bf16 v[96:111], v[52:55], v[68:71], v[96:111]
    s_add_u32 m0, s29, 8192
    s_nop 0
    buffer_load_dwordx4 v26, s[8:11], s6 offen lds
    v_mfma_f32_32x32x16_bf16 v[112:127], v[60:63], v[68:71], v[112:127]
    s_add_u32 m0, s29, 12288
    s_nop 0
    buffer_load_dwordx4 v27, s[8:11], s6 offen lds
    ds_read_b128 v[52:55], v43 offset:0
    ds_read_b128 v[60:63], v43 offset:4096
    ds_read_b128 v[68:71], v47 offset:0
    s_waitcnt lgkmcnt(3)
    v_mfma_f32_32x32x16_bf16 v[96:111], v[48:51], v[64:67], v[96:111]
    s_add_u32 m0, s29, 16384
    s_nop 0
    buffer_load_dwordx4 v28, s[12:15], s6 offen lds
    v_mfma_f32_32x32x16_bf16 v[112:127], v[56:59], v[64:67], v[112:127]
    s_add_u32 m0, s29, 20480
    s_nop 0
    buffer_load_dwordx4 v29, s[12:15], s6 offen lds
    s_waitcnt lgkmcnt(0)
    v_mfma_f32_32x32x16_bf16 v[96:111], v[52:55], v[68:71], v[96:111]
    v_mfma_f32_32x32x16_bf16 v[112:127], v[60:63], v[68:71], v[112:127]
    s_add_u32 s6, s6, 128
    s_cmp_ge_u32 s6, 896
    s_cselect_b32 s6, 0, s6
    s_add_u32 s29, s29, 24576
    s_cmp_ge_u32 s29, s30
    s_cselect_b32 s29, s28, s29
    s_add_u32 s31, s31, 1
    s_cmp_eq_u32 s31, 3
    s_cselect_b32 s33, s34, s35
    s_cselect_b32 s31, 0, s31
    v_add_u32 v40, s33, v40
    v_add_u32 v44, s33, v44
    v_add_u32 v41, s33, v41
    v_add_u32 v45, s33, v45
    v_add_u32 v42, s33, v42
    v_add_u32 v46, s33, v46
    v_add_u32 v43, s33, v43
    v_add_u32 v47, s33, v47
    s_waitcnt vmcnt(6)
    s_barrier
    s_add_u32 s7, s7, 1
    s_cmp_lt_u32 s7, 7
    s_cbranch_scc1 gemm1_kernel_loop
    s_waitcnt vmcnt(0)
    s_nop 15
    s_nop 3
    s_add_u32 s16, s90, 12582912
    s_addc_u32 s17, s91, 0
    s_mov_b32 s18, 7340032
    s_mov_b32 s19, 0x00020000
    s_mov_b32 s30, 0x3d372713
    s_mov_b32 s31, 0xc0135761
    v_add_u32 v3, v17, v13
    v_add_u32 v3, 0, v3
    v_add_u32 v3, s5, v3
    v_mul_u32_u24 v3, 3584, v3
    v_lshlrev_b32 v20, 2, v14
    v_add_u32 v20, v20, v16
    v_add_u32 v20, s4, v20
    v_lshlrev_b32 v20, 1, v20
    v_add_u32 v3, v3, v20
    v_cvt_pk_bf16_f32 v21, v96, v96
    v_lshlrev_b32 v96, 16, v21
    v_mul_f32 v21, v96, v96
    v_fma_f32 v21, v21, s30, 1.0
    v_mul_f32 v21, v21, v96
    v_mul_f32 v21, s31, v21
    v_exp_f32 v21, v21
    s_nop 0
    v_add_f32 v21, 1.0, v21
    v_rcp_f32 v21, v21
    s_nop 0
    v_mul_f32 v96, v96, v21
    v_cvt_pk_bf16_f32 v21, v97, v97
    v_lshlrev_b32 v97, 16, v21
    v_mul_f32 v21, v97, v97
    v_fma_f32 v21, v21, s30, 1.0
    v_mul_f32 v21, v21, v97
    v_mul_f32 v21, s31, v21
    v_exp_f32 v21, v21
    s_nop 0
    v_add_f32 v21, 1.0, v21
    v_rcp_f32 v21, v21
    s_nop 0
    v_mul_f32 v97, v97, v21
    v_cvt_pk_bf16_f32 v21, v98, v98
    v_lshlrev_b32 v98, 16, v21
    v_mul_f32 v21, v98, v98
    v_fma_f32 v21, v21, s30, 1.0
    v_mul_f32 v21, v21, v98
    v_mul_f32 v21, s31, v21
    v_exp_f32 v21, v21
    s_nop 0
    v_add_f32 v21, 1.0, v21
    v_rcp_f32 v21, v21
    s_nop 0
    v_mul_f32 v98, v98, v21
    v_cvt_pk_bf16_f32 v21, v99, v99
    v_lshlrev_b32 v99, 16, v21
    v_mul_f32 v21, v99, v99
    v_fma_f32 v21, v21, s30, 1.0
    v_mul_f32 v21, v21, v99
    v_mul_f32 v21, s31, v21
    v_exp_f32 v21, v21
    s_nop 0
    v_add_f32 v21, 1.0, v21
    v_rcp_f32 v21, v21
    s_nop 0
    v_mul_f32 v99, v99, v21
    v_cvt_pk_bf16_f32 v22, v96, v97
    v_cvt_pk_bf16_f32 v23, v98, v99
    buffer_store_dwordx2 v[22:23], v3, s[16:19], 0 offen offset:0
    v_cvt_pk_bf16_f32 v21, v100, v100
    v_lshlrev_b32 v100, 16, v21
    v_mul_f32 v21, v100, v100
    v_fma_f32 v21, v21, s30, 1.0
    v_mul_f32 v21, v21, v100
    v_mul_f32 v21, s31, v21
    v_exp_f32 v21, v21
    s_nop 0
    v_add_f32 v21, 1.0, v21
    v_rcp_f32 v21, v21
    s_nop 0
    v_mul_f32 v100, v100, v21
    v_cvt_pk_bf16_f32 v21, v101, v101
    v_lshlrev_b32 v101, 16, v21
    v_mul_f32 v21, v101, v101
    v_fma_f32 v21, v21, s30, 1.0
    v_mul_f32 v21, v21, v101
    v_mul_f32 v21, s31, v21
    v_exp_f32 v21, v21
    s_nop 0
    v_add_f32 v21, 1.0, v21
    v_rcp_f32 v21, v21
    s_nop 0
    v_mul_f32 v101, v101, v21
    v_cvt_pk_bf16_f32 v21, v102, v102
    v_lshlrev_b32 v102, 16, v21
    v_mul_f32 v21, v102, v102
    v_fma_f32 v21, v21, s30, 1.0
    v_mul_f32 v21, v21, v102
    v_mul_f32 v21, s31, v21
    v_exp_f32 v21, v21
    s_nop 0
    v_add_f32 v21, 1.0, v21
    v_rcp_f32 v21, v21
    s_nop 0
    v_mul_f32 v102, v102, v21
    v_cvt_pk_bf16_f32 v21, v103, v103
    v_lshlrev_b32 v103, 16, v21
    v_mul_f32 v21, v103, v103
    v_fma_f32 v21, v21, s30, 1.0
    v_mul_f32 v21, v21, v103
    v_mul_f32 v21, s31, v21
    v_exp_f32 v21, v21
    s_nop 0
    v_add_f32 v21, 1.0, v21
    v_rcp_f32 v21, v21
    s_nop 0
    v_mul_f32 v103, v103, v21
    v_cvt_pk_bf16_f32 v22, v100, v101
    v_cvt_pk_bf16_f32 v23, v102, v103
    buffer_store_dwordx2 v[22:23], v3, s[16:19], 0 offen offset:16
    v_cvt_pk_bf16_f32 v21, v104, v104
    v_lshlrev_b32 v104, 16, v21
    v_mul_f32 v21, v104, v104
    v_fma_f32 v21, v21, s30, 1.0
    v_mul_f32 v21, v21, v104
    v_mul_f32 v21, s31, v21
    v_exp_f32 v21, v21
    s_nop 0
    v_add_f32 v21, 1.0, v21
    v_rcp_f32 v21, v21
    s_nop 0
    v_mul_f32 v104, v104, v21
    v_cvt_pk_bf16_f32 v21, v105, v105
    v_lshlrev_b32 v105, 16, v21
    v_mul_f32 v21, v105, v105
    v_fma_f32 v21, v21, s30, 1.0
    v_mul_f32 v21, v21, v105
    v_mul_f32 v21, s31, v21
    v_exp_f32 v21, v21
    s_nop 0
    v_add_f32 v21, 1.0, v21
    v_rcp_f32 v21, v21
    s_nop 0
    v_mul_f32 v105, v105, v21
    v_cvt_pk_bf16_f32 v21, v106, v106
    v_lshlrev_b32 v106, 16, v21
    v_mul_f32 v21, v106, v106
    v_fma_f32 v21, v21, s30, 1.0
    v_mul_f32 v21, v21, v106
    v_mul_f32 v21, s31, v21
    v_exp_f32 v21, v21
    s_nop 0
    v_add_f32 v21, 1.0, v21
    v_rcp_f32 v21, v21
    s_nop 0
    v_mul_f32 v106, v106, v21
    v_cvt_pk_bf16_f32 v21, v107, v107
    v_lshlrev_b32 v107, 16, v21
    v_mul_f32 v21, v107, v107
    v_fma_f32 v21, v21, s30, 1.0
    v_mul_f32 v21, v21, v107
    v_mul_f32 v21, s31, v21
    v_exp_f32 v21, v21
    s_nop 0
    v_add_f32 v21, 1.0, v21
    v_rcp_f32 v21, v21
    s_nop 0
    v_mul_f32 v107, v107, v21
    v_cvt_pk_bf16_f32 v22, v104, v105
    v_cvt_pk_bf16_f32 v23, v106, v107
    buffer_store_dwordx2 v[22:23], v3, s[16:19], 0 offen offset:32
    v_cvt_pk_bf16_f32 v21, v108, v108
    v_lshlrev_b32 v108, 16, v21
    v_mul_f32 v21, v108, v108
    v_fma_f32 v21, v21, s30, 1.0
    v_mul_f32 v21, v21, v108
    v_mul_f32 v21, s31, v21
    v_exp_f32 v21, v21
    s_nop 0
    v_add_f32 v21, 1.0, v21
    v_rcp_f32 v21, v21
    s_nop 0
    v_mul_f32 v108, v108, v21
    v_cvt_pk_bf16_f32 v21, v109, v109
    v_lshlrev_b32 v109, 16, v21
    v_mul_f32 v21, v109, v109
    v_fma_f32 v21, v21, s30, 1.0
    v_mul_f32 v21, v21, v109
    v_mul_f32 v21, s31, v21
    v_exp_f32 v21, v21
    s_nop 0
    v_add_f32 v21, 1.0, v21
    v_rcp_f32 v21, v21
    s_nop 0
    v_mul_f32 v109, v109, v21
    v_cvt_pk_bf16_f32 v21, v110, v110
    v_lshlrev_b32 v110, 16, v21
    v_mul_f32 v21, v110, v110
    v_fma_f32 v21, v21, s30, 1.0
    v_mul_f32 v21, v21, v110
    v_mul_f32 v21, s31, v21
    v_exp_f32 v21, v21
    s_nop 0
    v_add_f32 v21, 1.0, v21
    v_rcp_f32 v21, v21
    s_nop 0
    v_mul_f32 v110, v110, v21
    v_cvt_pk_bf16_f32 v21, v111, v111
    v_lshlrev_b32 v111, 16, v21
    v_mul_f32 v21, v111, v111
    v_fma_f32 v21, v21, s30, 1.0
    v_mul_f32 v21, v21, v111
    v_mul_f32 v21, s31, v21
    v_exp_f32 v21, v21
    s_nop 0
    v_add_f32 v21, 1.0, v21
    v_rcp_f32 v21, v21
    s_nop 0
    v_mul_f32 v111, v111, v21
    v_cvt_pk_bf16_f32 v22, v108, v109
    v_cvt_pk_bf16_f32 v23, v110, v111
    buffer_store_dwordx2 v[22:23], v3, s[16:19], 0 offen offset:48
    v_cvt_pk_bf16_f32 v21, v112, v112
    v_lshlrev_b32 v112, 16, v21
    v_mul_f32 v21, v112, v112
    v_fma_f32 v21, v21, s30, 1.0
    v_mul_f32 v21, v21, v112
    v_mul_f32 v21, s31, v21
    v_exp_f32 v21, v21
    s_nop 0
    v_add_f32 v21, 1.0, v21
    v_rcp_f32 v21, v21
    s_nop 0
    v_mul_f32 v112, v112, v21
    v_cvt_pk_bf16_f32 v21, v113, v113
    v_lshlrev_b32 v113, 16, v21
    v_mul_f32 v21, v113, v113
    v_fma_f32 v21, v21, s30, 1.0
    v_mul_f32 v21, v21, v113
    v_mul_f32 v21, s31, v21
    v_exp_f32 v21, v21
    s_nop 0
    v_add_f32 v21, 1.0, v21
    v_rcp_f32 v21, v21
    s_nop 0
    v_mul_f32 v113, v113, v21
    v_cvt_pk_bf16_f32 v21, v114, v114
    v_lshlrev_b32 v114, 16, v21
    v_mul_f32 v21, v114, v114
    v_fma_f32 v21, v21, s30, 1.0
    v_mul_f32 v21, v21, v114
    v_mul_f32 v21, s31, v21
    v_exp_f32 v21, v21
    s_nop 0
    v_add_f32 v21, 1.0, v21
    v_rcp_f32 v21, v21
    s_nop 0
    v_mul_f32 v114, v114, v21
    v_cvt_pk_bf16_f32 v21, v115, v115
    v_lshlrev_b32 v115, 16, v21
    v_mul_f32 v21, v115, v115
    v_fma_f32 v21, v21, s30, 1.0
    v_mul_f32 v21, v21, v115
    v_mul_f32 v21, s31, v21
    v_exp_f32 v21, v21
    s_nop 0
    v_add_f32 v21, 1.0, v21
    v_rcp_f32 v21, v21
    s_nop 0
    v_mul_f32 v115, v115, v21
    v_cvt_pk_bf16_f32 v22, v112, v113
    v_cvt_pk_bf16_f32 v23, v114, v115
    buffer_store_dwordx2 v[22:23], v3, s[16:19], 0 offen offset:64
    v_cvt_pk_bf16_f32 v21, v116, v116
    v_lshlrev_b32 v116, 16, v21
    v_mul_f32 v21, v116, v116
    v_fma_f32 v21, v21, s30, 1.0
    v_mul_f32 v21, v21, v116
    v_mul_f32 v21, s31, v21
    v_exp_f32 v21, v21
    s_nop 0
    v_add_f32 v21, 1.0, v21
    v_rcp_f32 v21, v21
    s_nop 0
    v_mul_f32 v116, v116, v21
    v_cvt_pk_bf16_f32 v21, v117, v117
    v_lshlrev_b32 v117, 16, v21
    v_mul_f32 v21, v117, v117
    v_fma_f32 v21, v21, s30, 1.0
    v_mul_f32 v21, v21, v117
    v_mul_f32 v21, s31, v21
    v_exp_f32 v21, v21
    s_nop 0
    v_add_f32 v21, 1.0, v21
    v_rcp_f32 v21, v21
    s_nop 0
    v_mul_f32 v117, v117, v21
    v_cvt_pk_bf16_f32 v21, v118, v118
    v_lshlrev_b32 v118, 16, v21
    v_mul_f32 v21, v118, v118
    v_fma_f32 v21, v21, s30, 1.0
    v_mul_f32 v21, v21, v118
    v_mul_f32 v21, s31, v21
    v_exp_f32 v21, v21
    s_nop 0
    v_add_f32 v21, 1.0, v21
    v_rcp_f32 v21, v21
    s_nop 0
    v_mul_f32 v118, v118, v21
    v_cvt_pk_bf16_f32 v21, v119, v119
    v_lshlrev_b32 v119, 16, v21
    v_mul_f32 v21, v119, v119
    v_fma_f32 v21, v21, s30, 1.0
    v_mul_f32 v21, v21, v119
    v_mul_f32 v21, s31, v21
    v_exp_f32 v21, v21
    s_nop 0
    v_add_f32 v21, 1.0, v21
    v_rcp_f32 v21, v21
    s_nop 0
    v_mul_f32 v119, v119, v21
    v_cvt_pk_bf16_f32 v22, v116, v117
    v_cvt_pk_bf16_f32 v23, v118, v119
    buffer_store_dwordx2 v[22:23], v3, s[16:19], 0 offen offset:80
    v_cvt_pk_bf16_f32 v21, v120, v120
    v_lshlrev_b32 v120, 16, v21
    v_mul_f32 v21, v120, v120
    v_fma_f32 v21, v21, s30, 1.0
    v_mul_f32 v21, v21, v120
    v_mul_f32 v21, s31, v21
    v_exp_f32 v21, v21
    s_nop 0
    v_add_f32 v21, 1.0, v21
    v_rcp_f32 v21, v21
    s_nop 0
    v_mul_f32 v120, v120, v21
    v_cvt_pk_bf16_f32 v21, v121, v121
    v_lshlrev_b32 v121, 16, v21
    v_mul_f32 v21, v121, v121
    v_fma_f32 v21, v21, s30, 1.0
    v_mul_f32 v21, v21, v121
    v_mul_f32 v21, s31, v21
    v_exp_f32 v21, v21
    s_nop 0
    v_add_f32 v21, 1.0, v21
    v_rcp_f32 v21, v21
    s_nop 0
    v_mul_f32 v121, v121, v21
    v_cvt_pk_bf16_f32 v21, v122, v122
    v_lshlrev_b32 v122, 16, v21
    v_mul_f32 v21, v122, v122
    v_fma_f32 v21, v21, s30, 1.0
    v_mul_f32 v21, v21, v122
    v_mul_f32 v21, s31, v21
    v_exp_f32 v21, v21
    s_nop 0
    v_add_f32 v21, 1.0, v21
    v_rcp_f32 v21, v21
    s_nop 0
    v_mul_f32 v122, v122, v21
    v_cvt_pk_bf16_f32 v21, v123, v123
    v_lshlrev_b32 v123, 16, v21
    v_mul_f32 v21, v123, v123
    v_fma_f32 v21, v21, s30, 1.0
    v_mul_f32 v21, v21, v123
    v_mul_f32 v21, s31, v21
    v_exp_f32 v21, v21
    s_nop 0
    v_add_f32 v21, 1.0, v21
    v_rcp_f32 v21, v21
    s_nop 0
    v_mul_f32 v123, v123, v21
    v_cvt_pk_bf16_f32 v22, v120, v121
    v_cvt_pk_bf16_f32 v23, v122, v123
    buffer_store_dwordx2 v[22:23], v3, s[16:19], 0 offen offset:96
    v_cvt_pk_bf16_f32 v21, v124, v124
    v_lshlrev_b32 v124, 16, v21
    v_mul_f32 v21, v124, v124
    v_fma_f32 v21, v21, s30, 1.0
    v_mul_f32 v21, v21, v124
    v_mul_f32 v21, s31, v21
    v_exp_f32 v21, v21
    s_nop 0
    v_add_f32 v21, 1.0, v21
    v_rcp_f32 v21, v21
    s_nop 0
    v_mul_f32 v124, v124, v21
    v_cvt_pk_bf16_f32 v21, v125, v125
    v_lshlrev_b32 v125, 16, v21
    v_mul_f32 v21, v125, v125
    v_fma_f32 v21, v21, s30, 1.0
    v_mul_f32 v21, v21, v125
    v_mul_f32 v21, s31, v21
    v_exp_f32 v21, v21
    s_nop 0
    v_add_f32 v21, 1.0, v21
    v_rcp_f32 v21, v21
    s_nop 0
    v_mul_f32 v125, v125, v21
    v_cvt_pk_bf16_f32 v21, v126, v126
    v_lshlrev_b32 v126, 16, v21
    v_mul_f32 v21, v126, v126
    v_fma_f32 v21, v21, s30, 1.0
    v_mul_f32 v21, v21, v126
    v_mul_f32 v21, s31, v21
    v_exp_f32 v21, v21
    s_nop 0
    v_add_f32 v21, 1.0, v21
    v_rcp_f32 v21, v21
    s_nop 0
    v_mul_f32 v126, v126, v21
    v_cvt_pk_bf16_f32 v21, v127, v127
    v_lshlrev_b32 v127, 16, v21
    v_mul_f32 v21, v127, v127
    v_fma_f32 v21, v21, s30, 1.0
    v_mul_f32 v21, v21, v127
    v_mul_f32 v21, s31, v21
    v_exp_f32 v21, v21
    s_nop 0
    v_add_f32 v21, 1.0, v21
    v_rcp_f32 v21, v21
    s_nop 0
    v_mul_f32 v127, v127, v21
    v_cvt_pk_bf16_f32 v22, v124, v125
    v_cvt_pk_bf16_f32 v23, v126, v127
    buffer_store_dwordx2 v[22:23], v3, s[16:19], 0 offen offset:112
gemm1_kernel_end:
    s_endpgm
.globl ln2_kernel
.p2align 8
.type ln2_kernel,@function
ln2_kernel:
    s_cmp_ge_u32 s2, 128
    s_cbranch_scc1 ln2_kernel_end
    s_load_dwordx16 s[64:79], s[0:1], 0
    s_load_dwordx8 s[80:87], s[0:1], 64
    s_load_dwordx4 s[88:91], s[0:1], 96
    s_waitcnt lgkmcnt(0)
    s_add_u32 s8, s90, 12582912
    s_addc_u32 s9, s91, 0
    s_mov_b32 s10, 7340032
    s_mov_b32 s11, 0x00020000
    s_add_u32 s12, s90, 20971520
    s_addc_u32 s13, s91, 0
    s_mov_b32 s14, 3670016
    s_mov_b32 s15, 0x00020000
    v_and_b32 v1, 63, v0
    v_lshrrev_b32 v3, 6, v0
    s_lshl_b32 s5, s2, 4
    v_add_u32 v4, s5, v3
    v_mul_u32_u24 v4, 3584, v4
    v_lshlrev_b32 v5, 1, v1
    v_add_u32 v4, v4, v5
    buffer_load_ushort v10, v4, s[8:11], 0 offen offset:1792
    buffer_load_ushort v11, v4, s[8:11], 0 offen offset:1920
    buffer_load_ushort v12, v4, s[8:11], 0 offen offset:2048
    buffer_load_ushort v13, v4, s[8:11], 0 offen offset:2176
    buffer_load_ushort v14, v4, s[8:11], 0 offen offset:2304
    buffer_load_ushort v15, v4, s[8:11], 0 offen offset:2432
    buffer_load_ushort v16, v4, s[8:11], 0 offen offset:2560
    buffer_load_ushort v17, v4, s[8:11], 0 offen offset:2688
    buffer_load_ushort v18, v4, s[8:11], 0 offen offset:2816
    buffer_load_ushort v19, v4, s[8:11], 0 offen offset:2944
    buffer_load_ushort v20, v4, s[8:11], 0 offen offset:3072
    buffer_load_ushort v21, v4, s[8:11], 0 offen offset:3200
    buffer_load_ushort v22, v4, s[8:11], 0 offen offset:3328
    buffer_load_ushort v23, v4, s[8:11], 0 offen offset:3456
    s_waitcnt vmcnt(0)
    v_lshlrev_b32 v10, 16, v10
    v_lshlrev_b32 v11, 16, v11
    v_lshlrev_b32 v12, 16, v12
    v_lshlrev_b32 v13, 16, v13
    v_lshlrev_b32 v14, 16, v14
    v_lshlrev_b32 v15, 16, v15
    v_lshlrev_b32 v16, 16, v16
    v_lshlrev_b32 v17, 16, v17
    v_lshlrev_b32 v18, 16, v18
    v_lshlrev_b32 v19, 16, v19
    v_lshlrev_b32 v20, 16, v20
    v_lshlrev_b32 v21, 16, v21
    v_lshlrev_b32 v22, 16, v22
    v_lshlrev_b32 v23, 16, v23
    v_mov_b32 v40, v10
    v_add_f32 v40, v40, v11
    v_add_f32 v40, v40, v12
    v_add_f32 v40, v40, v13
    v_add_f32 v40, v40, v14
    v_add_f32 v40, v40, v15
    v_add_f32 v40, v40, v16
    v_add_f32 v40, v40, v17
    v_add_f32 v40, v40, v18
    v_add_f32 v40, v40, v19
    v_add_f32 v40, v40, v20
    v_add_f32 v40, v40, v21
    v_add_f32 v40, v40, v22
    v_add_f32 v40, v40, v23
    ds_swizzle_b32 v43, v40 offset:0x41f
    s_waitcnt lgkmcnt(0)
    v_add_f32 v40, v40, v43
    ds_swizzle_b32 v43, v40 offset:0x81f
    s_waitcnt lgkmcnt(0)
    v_add_f32 v40, v40, v43
    ds_swizzle_b32 v43, v40 offset:0x101f
    s_waitcnt lgkmcnt(0)
    v_add_f32 v40, v40, v43
    ds_swizzle_b32 v43, v40 offset:0x201f
    s_waitcnt lgkmcnt(0)
    v_add_f32 v40, v40, v43
    ds_swizzle_b32 v43, v40 offset:0x401f
    s_waitcnt lgkmcnt(0)
    v_add_f32 v40, v40, v43
    s_nop 1
    v_readlane_b32 s98, v40, 0
    v_readlane_b32 s99, v40, 32
    s_nop 3
    v_mov_b32 v40, s98
    v_add_f32 v40, s99, v40
    v_mul_f32 v41, 0x3a924925, v40
    v_mov_b32 v40, 0
    v_sub_f32 v42, v10, v41
    v_fmac_f32 v40, v42, v42
    v_sub_f32 v42, v11, v41
    v_fmac_f32 v40, v42, v42
    v_sub_f32 v42, v12, v41
    v_fmac_f32 v40, v42, v42
    v_sub_f32 v42, v13, v41
    v_fmac_f32 v40, v42, v42
    v_sub_f32 v42, v14, v41
    v_fmac_f32 v40, v42, v42
    v_sub_f32 v42, v15, v41
    v_fmac_f32 v40, v42, v42
    v_sub_f32 v42, v16, v41
    v_fmac_f32 v40, v42, v42
    v_sub_f32 v42, v17, v41
    v_fmac_f32 v40, v42, v42
    v_sub_f32 v42, v18, v41
    v_fmac_f32 v40, v42, v42
    v_sub_f32 v42, v19, v41
    v_fmac_f32 v40, v42, v42
    v_sub_f32 v42, v20, v41
    v_fmac_f32 v40, v42, v42
    v_sub_f32 v42, v21, v41
    v_fmac_f32 v40, v42, v42
    v_sub_f32 v42, v22, v41
    v_fmac_f32 v40, v42, v42
    v_sub_f32 v42, v23, v41
    v_fmac_f32 v40, v42, v42
    ds_swizzle_b32 v43, v40 offset:0x41f
    s_waitcnt lgkmcnt(0)
    v_add_f32 v40, v40, v43
    ds_swizzle_b32 v43, v40 offset:0x81f
    s_waitcnt lgkmcnt(0)
    v_add_f32 v40, v40, v43
    ds_swizzle_b32 v43, v40 offset:0x101f
    s_waitcnt lgkmcnt(0)
    v_add_f32 v40, v40, v43
    ds_swizzle_b32 v43, v40 offset:0x201f
    s_waitcnt lgkmcnt(0)
    v_add_f32 v40, v40, v43
    ds_swizzle_b32 v43, v40 offset:0x401f
    s_waitcnt lgkmcnt(0)
    v_add_f32 v40, v40, v43
    s_nop 1
    v_readlane_b32 s98, v40, 0
    v_readlane_b32 s99, v40, 32
    s_nop 3
    v_mov_b32 v40, s98
    v_add_f32 v40, s99, v40
    v_mul_f32 v40, 0x3a924925, v40
    v_cvt_pk_bf16_f32 v43, v40, v40
    v_lshlrev_b32 v40, 16, v43
    v_cvt_pk_bf16_f32 v43, v41, v41
    v_lshlrev_b32 v41, 16, v43
    v_add_f32 v40, 0x3727c5ac, v40
    v_cvt_pk_bf16_f32 v43, v40, v40
    v_lshlrev_b32 v40, 16, v43
    v_sqrt_f32 v40, v40
    s_nop 0
    v_cvt_pk_bf16_f32 v43, v40, v40
    v_lshlrev_b32 v40, 16, v43
    v_rcp_f32 v42, v40
    s_nop 0
    v_fma_f32 v43, -v40, v42, 1.0
    v_fmac_f32 v42, v43, v42
    v_sub_f32 v10, v10, v41
    v_cvt_pk_bf16_f32 v43, v10, v10
    v_lshlrev_b32 v10, 16, v43
    v_mul_f32 v10, v10, v42
    v_cvt_pk_bf16_f32 v43, v10, v10
    v_lshlrev_b32 v10, 16, v43
    v_sub_f32 v11, v11, v41
    v_cvt_pk_bf16_f32 v43, v11, v11
    v_lshlrev_b32 v11, 16, v43
    v_mul_f32 v11, v11, v42
    v_cvt_pk_bf16_f32 v43, v11, v11
    v_lshlrev_b32 v11, 16, v43
    v_sub_f32 v12, v12, v41
    v_cvt_pk_bf16_f32 v43, v12, v12
    v_lshlrev_b32 v12, 16, v43
    v_mul_f32 v12, v12, v42
    v_cvt_pk_bf16_f32 v43, v12, v12
    v_lshlrev_b32 v12, 16, v43
    v_sub_f32 v13, v13, v41
    v_cvt_pk_bf16_f32 v43, v13, v13
    v_lshlrev_b32 v13, 16, v43
    v_mul_f32 v13, v13, v42
    v_cvt_pk_bf16_f32 v43, v13, v13
    v_lshlrev_b32 v13, 16, v43
    v_sub_f32 v14, v14, v41
    v_cvt_pk_bf16_f32 v43, v14, v14
    v_lshlrev_b32 v14, 16, v43
    v_mul_f32 v14, v14, v42
    v_cvt_pk_bf16_f32 v43, v14, v14
    v_lshlrev_b32 v14, 16, v43
    v_sub_f32 v15, v15, v41
    v_cvt_pk_bf16_f32 v43, v15, v15
    v_lshlrev_b32 v15, 16, v43
    v_mul_f32 v15, v15, v42
    v_cvt_pk_bf16_f32 v43, v15, v15
    v_lshlrev_b32 v15, 16, v43
    v_sub_f32 v16, v16, v41
    v_cvt_pk_bf16_f32 v43, v16, v16
    v_lshlrev_b32 v16, 16, v43
    v_mul_f32 v16, v16, v42
    v_cvt_pk_bf16_f32 v43, v16, v16
    v_lshlrev_b32 v16, 16, v43
    v_sub_f32 v17, v17, v41
    v_cvt_pk_bf16_f32 v43, v17, v17
    v_lshlrev_b32 v17, 16, v43
    v_mul_f32 v17, v17, v42
    v_cvt_pk_bf16_f32 v43, v17, v17
    v_lshlrev_b32 v17, 16, v43
    v_sub_f32 v18, v18, v41
    v_cvt_pk_bf16_f32 v43, v18, v18
    v_lshlrev_b32 v18, 16, v43
    v_mul_f32 v18, v18, v42
    v_cvt_pk_bf16_f32 v43, v18, v18
    v_lshlrev_b32 v18, 16, v43
    v_sub_f32 v19, v19, v41
    v_cvt_pk_bf16_f32 v43, v19, v19
    v_lshlrev_b32 v19, 16, v43
    v_mul_f32 v19, v19, v42
    v_cvt_pk_bf16_f32 v43, v19, v19
    v_lshlrev_b32 v19, 16, v43
    v_sub_f32 v20, v20, v41
    v_cvt_pk_bf16_f32 v43, v20, v20
    v_lshlrev_b32 v20, 16, v43
    v_mul_f32 v20, v20, v42
    v_cvt_pk_bf16_f32 v43, v20, v20
    v_lshlrev_b32 v20, 16, v43
    v_sub_f32 v21, v21, v41
    v_cvt_pk_bf16_f32 v43, v21, v21
    v_lshlrev_b32 v21, 16, v43
    v_mul_f32 v21, v21, v42
    v_cvt_pk_bf16_f32 v43, v21, v21
    v_lshlrev_b32 v21, 16, v43
    v_sub_f32 v22, v22, v41
    v_cvt_pk_bf16_f32 v43, v22, v22
    v_lshlrev_b32 v22, 16, v43
    v_mul_f32 v22, v22, v42
    v_cvt_pk_bf16_f32 v43, v22, v22
    v_lshlrev_b32 v22, 16, v43
    v_sub_f32 v23, v23, v41
    v_cvt_pk_bf16_f32 v43, v23, v23
    v_lshlrev_b32 v23, 16, v43
    v_mul_f32 v23, v23, v42
    v_cvt_pk_bf16_f32 v43, v23, v23
    v_lshlrev_b32 v23, 16, v43
    v_mul_u32_u24 v6, 48, v1
    v_lshlrev_b32 v5, 1, v3
    v_add_u32 v6, v6, v5
    v_lshrrev_b32 v45, 16, v10
    ds_write_b16 v6, v45 offset:0
    v_lshrrev_b32 v45, 16, v11
    ds_write_b16 v6, v45 offset:3072
    v_lshrrev_b32 v45, 16, v12
    ds_write_b16 v6, v45 offset:6144
    v_lshrrev_b32 v45, 16, v13
    ds_write_b16 v6, v45 offset:9216
    v_lshrrev_b32 v45, 16, v14
    ds_write_b16 v6, v45 offset:12288
    v_lshrrev_b32 v45, 16, v15
    ds_write_b16 v6, v45 offset:15360
    v_lshrrev_b32 v45, 16, v16
    ds_write_b16 v6, v45 offset:18432
    v_lshrrev_b32 v45, 16, v17
    ds_write_b16 v6, v45 offset:21504
    v_lshrrev_b32 v45, 16, v18
    ds_write_b16 v6, v45 offset:24576
    v_lshrrev_b32 v45, 16, v19
    ds_write_b16 v6, v45 offset:27648
    v_lshrrev_b32 v45, 16, v20
    ds_write_b16 v6, v45 offset:30720
    v_lshrrev_b32 v45, 16, v21
    ds_write_b16 v6, v45 offset:33792
    v_lshrrev_b32 v45, 16, v22
    ds_write_b16 v6, v45 offset:36864
    v_lshrrev_b32 v45, 16, v23
    ds_write_b16 v6, v45 offset:39936
    s_waitcnt lgkmcnt(0)
    s_barrier
    s_lshl_b32 s4, s2, 5
    v_lshrrev_b32 v1, 1, v0
    v_and_b32 v2, 1, v0
    v_add_u32 v3, 0, v1
    v_mul_u32_u24 v4, 48, v3
    v_lshlrev_b32 v5, 4, v2
    v_add_u32 v4, v4, v5
    ds_read_b128 v[8:11], v4
    v_lshlrev_b32 v4, 12, v3
    v_add_u32 v4, v4, v5
    s_waitcnt lgkmcnt(0)
    buffer_store_dwordx4 v[8:11], v4, s[12:15], s4 offen
    v_add_u32 v3, 512, v1
    v_cmp_gt_u32 vcc, 896, v3
    s_and_saveexec_b64 s[24:25], vcc
    s_cbranch_execz ln2_kernel_end
    v_mul_u32_u24 v4, 48, v3
    v_lshlrev_b32 v5, 4, v2
    v_add_u32 v4, v4, v5
    ds_read_b128 v[8:11], v4
    v_lshlrev_b32 v4, 12, v3
    v_add_u32 v4, v4, v5
    s_waitcnt lgkmcnt(0)
    buffer_store_dwordx4 v[8:11], v4, s[12:15], s4 offen
ln2_kernel_end:
    s_endpgm
.globl gemm2_kernel
.p2align 8
.type gemm2_kernel,@function
gemm2_kernel:
    s_cmp_ge_u32 s2, 224
    s_cbranch_scc1 gemm2_kernel_end
    s_load_dwordx16 s[64:79], s[0:1], 0
    s_load_dwordx8 s[80:87], s[0:1], 64
    s_load_dwordx4 s[88:91], s[0:1], 96
    s_waitcnt lgkmcnt(0)
    s_add_u32 s8, s90, 20971520
    s_addc_u32 s9, s91, 0
    s_mov_b32 s10, 3670016
    s_mov_b32 s11, 0x00020000
    s_add_u32 s12, s80, 0
    s_addc_u32 s13, s81, 0
    s_mov_b32 s14, 8388608
    s_mov_b32 s15, 0x00020000
    s_and_b32 s5, s2, 31
    s_lshr_b32 s4, s2, 5
    s_lshl_b32 s4, s4, 7
    s_lshl_b32 s5, s5, 6
    s_mov_b32 s26, 4096
    s_mov_b32 s27, 4096
    v_lshrrev_b32 v15, 6, v0
    v_and_b32 v1, 63, v0
    v_lshrrev_b32 v2, 3, v1
    v_and_b32 v3, 7, v1
    s_nop 0
    v_readfirstlane_b32 s28, v15
    s_nop 3
    s_lshl_b32 s28, s28, 10
    v_lshlrev_b32 v20, 3, v15
    v_add_u32 v20, 0, v20
    v_add_u32 v20, v20, v2
    v_bfe_u32 v21, v20, 1, 3
    v_xor_b32 v21, v21, v3
    v_lshlrev_b32 v21, 4, v21
    v_add_u32 v20, s4, v20
    v_mul_lo_u32 v20, v20, s26
    v_add_u32 v24, v20, v21
    v_lshlrev_b32 v20, 3, v15
    v_add_u32 v20, 32, v20
    v_add_u32 v20, v20, v2
    v_bfe_u32 v21, v20, 1, 3
    v_xor_b32 v21, v21, v3
    v_lshlrev_b32 v21, 4, v21
    v_add_u32 v20, s4, v20
    v_mul_lo_u32 v20, v20, s26
    v_add_u32 v25, v20, v21
    v_lshlrev_b32 v20, 3, v15
    v_add_u32 v20, 64, v20
    v_add_u32 v20, v20, v2
    v_bfe_u32 v21, v20, 1, 3
    v_xor_b32 v21, v21, v3
    v_lshlrev_b32 v21, 4, v21
    v_add_u32 v20, s4, v20
    v_mul_lo_u32 v20, v20, s26
    v_add_u32 v26, v20, v21
    v_lshlrev_b32 v20, 3, v15
    v_add_u32 v20, 96, v20
    v_add_u32 v20, v20, v2
    v_bfe_u32 v21, v20, 1, 3
    v_xor_b32 v21, v21, v3
    v_lshlrev_b32 v21, 4, v21
    v_add_u32 v20, s4, v20
    v_mul_lo_u32 v20, v20, s26
    v_add_u32 v27, v20, v21
    v_lshlrev_b32 v20, 3, v15
    v_add_u32 v20, 0, v20
    v_add_u32 v20, v20, v2
    v_bfe_u32 v21, v20, 1, 3
    v_xor_b32 v21, v21, v3
    v_lshlrev_b32 v21, 4, v21
    v_add_u32 v20, s5, v20
    v_mul_lo_u32 v20, v20, s27
    v_add_u32 v28, v20, v21
    v_lshlrev_b32 v20, 3, v15
    v_add_u32 v20, 32, v20
    v_add_u32 v20, v20, v2
    v_bfe_u32 v21, v20, 1, 3
    v_xor_b32 v21, v21, v3
    v_lshlrev_b32 v21, 4, v21
    v_add_u32 v20, s5, v20
    v_mul_lo_u32 v20, v20, s27
    v_add_u32 v29, v20, v21
    v_and_b32 v13, 31, v0
    v_bfe_u32 v14, v0, 5, 1
    v_and_b32 v16, 1, v15
    v_lshrrev_b32 v17, 1, v15
    v_mul_u32_u24 v16, 64, v16
    v_mul_u32_u24 v17, 32, v17
    v_add_u32 v20, v16, v13
    v_bfe_u32 v21, v20, 1, 3
    v_and_b32 v22, 1, v21
    v_xor_b32 v22, v22, v14
    v_lshlrev_b32 v22, 4, v22
    v_lshlrev_b32 v20, 7, v20
    v_add_u32 v20, v20, v22
    v_add_u32 v20, 0, v20
    v_lshrrev_b32 v21, 1, v21
    v_xor_b32 v22, 0, v21
    v_lshlrev_b32 v22, 5, v22
    v_add_u32 v40, v20, v22
    v_xor_b32 v22, 1, v21
    v_lshlrev_b32 v22, 5, v22
    v_add_u32 v41, v20, v22
    v_xor_b32 v22, 2, v21
    v_lshlrev_b32 v22, 5, v22
    v_add_u32 v42, v20, v22
    v_xor_b32 v22, 3, v21
    v_lshlrev_b32 v22, 5, v22
    v_add_u32 v43, v20, v22
    v_add_u32 v20, v17, v13
    v_bfe_u32 v21, v20, 1, 3
    v_and_b32 v22, 1, v21
    v_xor_b32 v22, v22, v14
    v_lshlrev_b32 v22, 4, v22
    v_lshlrev_b32 v20, 7, v20
    v_add_u32 v20, v20, v22
    v_add_u32 v20, 16384, v20
    v_lshrrev_b32 v21, 1, v21
    v_xor_b32 v22, 0, v21
    v_lshlrev_b32 v22, 5, v22
    v_add_u32 v44, v20, v22
    v_xor_b32 v22, 1, v21
    v_lshlrev_b32 v22, 5, v22
    v_add_u32 v45, v20, v22
    v_xor_b32 v22, 2, v21
    v_lshlrev_b32 v22, 5, v22
    v_add_u32 v46, v20, v22
    v_xor_b32 v22, 3, v21
    v_lshlrev_b32 v22, 5, v22
    v_add_u32 v47, v20, v22
    v_mov_b32 v96, 0
    v_mov_b32 v97, 0
    v_mov_b32 v98, 0
    v_mov_b32 v99, 0
    v_mov_b32 v100, 0
    v_mov_b32 v101, 0
    v_mov_b32 v102, 0
    v_mov_b32 v103, 0
    v_mov_b32 v104, 0
    v_mov_b32 v105, 0
    v_mov_b32 v106, 0
    v_mov_b32 v107, 0
    v_mov_b32 v108, 0
    v_mov_b32 v109, 0
    v_mov_b32 v110, 0
    v_mov_b32 v111, 0
    v_mov_b32 v112, 0
    v_mov_b32 v113, 0
    v_mov_b32 v114, 0
    v_mov_b32 v115, 0
    v_mov_b32 v116, 0
    v_mov_b32 v117, 0
    v_mov_b32 v118, 0
    v_mov_b32 v119, 0
    v_mov_b32 v120, 0
    v_mov_b32 v121, 0
    v_mov_b32 v122, 0
    v_mov_b32 v123, 0
    v_mov_b32 v124, 0
    v_mov_b32 v125, 0
    v_mov_b32 v126, 0
    v_mov_b32 v127, 0
    s_mul_i32 s6, s2, 5
    s_lshr_b32 s33, s2, 3
    s_add_u32 s6, s6, s33
    s_mul_hi_u32 s33, s6, 134217729
    s_mul_i32 s33, s33, 32
    s_sub_u32 s6, s6, s33
    s_lshl_b32 s6, s6, 7
    s_mov_b32 s29, s28
    s_add_u32 s30, s28, 98304
    s_mov_b32 s31, 0
    s_mov_b32 s34, 4294893568
    s_mov_b32 s35, 24576
    s_add_u32 s16, s90, 12582912
    s_addc_u32 s17, s91, 0
    s_mov_b32 s18, 7340032
    s_mov_b32 s19, 0x00020000
    s_add_u32 s20, s90, 25165824
    s_addc_u32 s21, s91, 0
    s_mov_b32 s22, 3670016
    s_mov_b32 s23, 0x00020000
    s_add_u32 s36, s82, 0
    s_addc_u32 s37, s83, 0
    s_mov_b32 s38, 4096
    s_mov_b32 s39, 0x00020000
    v_add_u32 v3, v17, v13
    v_add_u32 v3, s5, v3
    v_lshlrev_b32 v21, 1, v3
    buffer_load_ushort v160, v21, s[36:39], 0 offen
    v_lshlrev_b32 v20, 2, v14
    v_add_u32 v20, v20, v16
    v_add_u32 v20, s4, v20
    v_lshlrev_b32 v20, 1, v20
    v_mul_u32_u24 v21, 3584, v3
    v_add_u32 v21, v21, v20
    v_mul_u32_u24 v3, 1792, v3
    v_add_u32 v161, v3, v20
    buffer_load_dwordx2 v[128:129], v21, s[16:19], 0 offen offset:0
    buffer_load_dwordx2 v[130:131], v21, s[16:19], 0 offen offset:16
    buffer_load_dwordx2 v[132:133], v21, s[16:19], 0 offen offset:32
    buffer_load_dwordx2 v[134:135], v21, s[16:19], 0 offen offset:48
    buffer_load_dwordx2 v[136:137], v21, s[16:19], 0 offen offset:64
    buffer_load_dwordx2 v[138:139], v21, s[16:19], 0 offen offset:80
    buffer_load_dwordx2 v[140:141], v21, s[16:19], 0 offen offset:96
    buffer_load_dwordx2 v[142:143], v21, s[16:19], 0 offen offset:112
    s_add_u32 m0, s29, 0
    s_nop 0
    buffer_load_dwordx4 v24, s[8:11], s6 offen lds
    s_add_u32 m0, s29, 4096
    s_nop 0
    buffer_load_dwordx4 v25, s[8:11], s6 offen lds
    s_add_u32 m0, s29, 8192
    s_nop 0
    buffer_load_dwordx4 v26, s[8:11], s6 offen lds
    s_add_u32 m0, s29, 12288
    s_nop 0
    buffer_load_dwordx4 v27, s[8:11], s6 offen lds
    s_add_u32 m0, s29, 16384
    s_nop 0
    buffer_load_dwordx4 v28, s[12:15], s6 offen lds
    s_add_u32 m0, s29, 20480
    s_nop 0
    buffer_load_dwordx4 v29, s[12:15], s6 offen lds
    s_add_u32 s6, s6, 128
    s_cmp_ge_u32 s6, 4096
    s_cselect_b32 s6, 0, s6
    s_add_u32 s29, s29, 24576
    s_cmp_ge_u32 s29, s30
    s_cselect_b32 s29, s28, s29
    s_add_u32 m0, s29, 0
    s_nop 0
    buffer_load_dwordx4 v24, s[8:11], s6 offen lds
    s_add_u32 m0, s29, 4096
    s_nop 0
    buffer_load_dwordx4 v25, s[8:11], s6 offen lds
    s_add_u32 m0, s29, 8192
    s_nop 0
    buffer_load_dwordx4 v26, s[8:11], s6 offen lds
    s_add_u32 m0, s29, 12288
    s_nop 0
    buffer_load_dwordx4 v27, s[8:11], s6 offen lds
    s_add_u32 m0, s29, 16384
    s_nop 0
    buffer_load_dwordx4 v28, s[12:15], s6 offen lds
    s_add_u32 m0, s29, 20480
    s_nop 0
    buffer_load_dwordx4 v29, s[12:15], s6 offen lds
    s_add_u32 s6, s6, 128
    s_cmp_ge_u32 s6, 4096
    s_cselect_b32 s6, 0, s6
    s_add_u32 s29, s29, 24576
    s_cmp_ge_u32 s29, s30
    s_cselect_b32 s29, s28, s29
    s_add_u32 m0, s29, 0
    s_nop 0
    buffer_load_dwordx4 v24, s[8:11], s6 offen lds
    s_add_u32 m0, s29, 4096
    s_nop 0
    buffer_load_dwordx4 v25, s[8:11], s6 offen lds
    s_add_u32 m0, s29, 8192
    s_nop 0
    buffer_load_dwordx4 v26, s[8:11], s6 offen lds
    s_add_u32 m0, s29, 12288
    s_nop 0
    buffer_load_dwordx4 v27, s[8:11], s6 offen lds
    s_add_u32 m0, s29, 16384
    s_nop 0
    buffer_load_dwordx4 v28, s[12:15], s6 offen lds
    s_add_u32 m0, s29, 20480
    s_nop 0
    buffer_load_dwordx4 v29, s[12:15], s6 offen lds
    s_add_u32 s6, s6, 128
    s_cmp_ge_u32 s6, 4096
    s_cselect_b32 s6, 0, s6
    s_add_u32 s29, s29, 24576
    s_cmp_ge_u32 s29, s30
    s_cselect_b32 s29, s28, s29
    s_waitcnt vmcnt(12)
    s_barrier
    s_mov_b32 s7, 0
gemm2_kernel_loop:
    ds_read_b128 v[48:51], v40 offset:0
    ds_read_b128 v[56:59], v40 offset:4096
    ds_read_b128 v[64:67], v44 offset:0
    ds_read_b128 v[52:55], v41 offset:0
    ds_read_b128 v[60:63], v41 offset:4096
    ds_read_b128 v[68:71], v45 offset:0
    s_waitcnt lgkmcnt(3)
    v_mfma_f32_32x32x16_bf16 v[96:111], v[48:51], v[64:67], v[96:111]
    s_add_u32 m0, s29, 0
    s_nop 0
    buffer_load_dwordx4 v24, s[8:11], s6 offen lds
    v_mfma_f32_32x32x16_bf16 v[112:127], v[56:59], v[64:67], v[112:127]
    s_add_u32 m0, s29, 4096
    s_nop 0
    buffer_load_dwordx4 v25, s[8:11], s6 offen lds
    ds_read_b128 v[48:51], v42 offset:0
    ds_read_b128 v[56:59], v42 offset:4096
    ds_read_b128 v[64:67], v46 offset:0
    s_waitcnt lgkmcnt(3)
    v_mfma_f32_32x32x16_bf16 v[96:111], v[52:55], v[68:71], v[96:111]
    s_add_u32 m0, s29, 8192
    s_nop 0
    buffer_load_dwordx4 v26, s[8:11], s6 offen lds
    v_mfma_f32_32x32x16_bf16 v[112:127], v[60:63], v[68:71], v[112:127]
    s_add_u32 m0, s29, 12288
    s_nop 0
    buffer_load_dwordx4 v27, s[8:11], s6 offen lds
    ds_read_b128 v[52:55], v43 offset:0
    ds_read_b128 v[60:63], v43 offset:4096
    ds_read_b128 v[68:71], v47 offset:0
    s_waitcnt lgkmcnt(3)
    v_mfma_f32_32x32x16_bf16 v[96:111], v[48:51], v[64:67], v[96:111]
    s_add_u32 m0, s29, 16384
    s_nop 0
    buffer_load_dwordx4 v28, s[12:15], s6 offen lds
    v_mfma_f32_32x32x16_bf16 v[112:127], v[56:59], v[64:67], v[112:127]
    s_add_u32 m0, s29, 20480
    s_nop 0
    buffer_load_dwordx4 v29, s[12:15], s6 offen lds
    s_waitcnt lgkmcnt(0)
    v_mfma_f32_32x32x16_bf16 v[96:111], v[52:55], v[68:71], v[96:111]
    v_mfma_f32_32x32x16_bf16 v[112:127], v[60:63], v[68:71], v[112:127]
    s_add_u32 s6, s6, 128
    s_cmp_ge_u32 s6, 4096
    s_cselect_b32 s6, 0, s6
    s_add_u32 s29, s29, 24576
    s_cmp_ge_u32 s29, s30
    s_cselect_b32 s29, s28, s29
    s_add_u32 s31, s31, 1
    s_cmp_eq_u32 s31, 4
    s_cselect_b32 s33, s34, s35
    s_cselect_b32 s31, 0, s31
    v_add_u32 v40, s33, v40
    v_add_u32 v44, s33, v44
    v_add_u32 v41, s33, v41
    v_add_u32 v45, s33, v45
    v_add_u32 v42, s33, v42
    v_add_u32 v46, s33, v46
    v_add_u32 v43, s33, v43
    v_add_u32 v47, s33, v47
    s_waitcnt vmcnt(12)
    s_barrier
    s_add_u32 s7, s7, 1
    s_cmp_lt_u32 s7, 32
    s_cbranch_scc1 gemm2_kernel_loop
    s_waitcnt vmcnt(0)
    s_nop 15
    s_nop 3
    v_lshlrev_b32 v24, 16, v160
    v_cvt_pk_bf16_f32 v25, v96, v96
    v_lshlrev_b32 v96, 16, v25
    v_add_f32 v96, v96, v24
    v_cvt_pk_bf16_f32 v25, v96, v96
    v_lshlrev_b32 v96, 16, v25
    v_cvt_pk_bf16_f32 v25, v97, v97
    v_lshlrev_b32 v97, 16, v25
    v_add_f32 v97, v97, v24
    v_cvt_pk_bf16_f32 v25, v97, v97
    v_lshlrev_b32 v97, 16, v25
    v_cvt_pk_bf16_f32 v25, v98, v98
    v_lshlrev_b32 v98, 16, v25
    v_add_f32 v98, v98, v24
    v_cvt_pk_bf16_f32 v25, v98, v98
    v_lshlrev_b32 v98, 16, v25
    v_cvt_pk_bf16_f32 v25, v99, v99
    v_lshlrev_b32 v99, 16, v25
    v_add_f32 v99, v99, v24
    v_cvt_pk_bf16_f32 v25, v99, v99
    v_lshlrev_b32 v99, 16, v25
    v_lshlrev_b32 v28, 16, v128
    v_mul_f32 v96, v96, v28
    v_and_b32 v28, 0xffff0000, v128
    v_mul_f32 v97, v97, v28
    v_lshlrev_b32 v28, 16, v129
    v_mul_f32 v98, v98, v28
    v_and_b32 v28, 0xffff0000, v129
    v_mul_f32 v99, v99, v28
    v_cvt_pk_bf16_f32 v96, v96, v97
    v_cvt_pk_bf16_f32 v97, v98, v99
    buffer_store_dwordx2 v[96:97], v161, s[20:23], 0 offen offset:0
    v_cvt_pk_bf16_f32 v25, v100, v100
    v_lshlrev_b32 v100, 16, v25
    v_add_f32 v100, v100, v24
    v_cvt_pk_bf16_f32 v25, v100, v100
    v_lshlrev_b32 v100, 16, v25
    v_cvt_pk_bf16_f32 v25, v101, v101
    v_lshlrev_b32 v101, 16, v25
    v_add_f32 v101, v101, v24
    v_cvt_pk_bf16_f32 v25, v101, v101
    v_lshlrev_b32 v101, 16, v25
    v_cvt_pk_bf16_f32 v25, v102, v102
    v_lshlrev_b32 v102, 16, v25
    v_add_f32 v102, v102, v24
    v_cvt_pk_bf16_f32 v25, v102, v102
    v_lshlrev_b32 v102, 16, v25
    v_cvt_pk_bf16_f32 v25, v103, v103
    v_lshlrev_b32 v103, 16, v25
    v_add_f32 v103, v103, v24
    v_cvt_pk_bf16_f32 v25, v103, v103
    v_lshlrev_b32 v103, 16, v25
    v_lshlrev_b32 v28, 16, v130
    v_mul_f32 v100, v100, v28
    v_and_b32 v28, 0xffff0000, v130
    v_mul_f32 v101, v101, v28
    v_lshlrev_b32 v28, 16, v131
    v_mul_f32 v102, v102, v28
    v_and_b32 v28, 0xffff0000, v131
    v_mul_f32 v103, v103, v28
    v_cvt_pk_bf16_f32 v100, v100, v101
    v_cvt_pk_bf16_f32 v101, v102, v103
    buffer_store_dwordx2 v[100:101], v161, s[20:23], 0 offen offset:16
    v_cvt_pk_bf16_f32 v25, v104, v104
    v_lshlrev_b32 v104, 16, v25
    v_add_f32 v104, v104, v24
    v_cvt_pk_bf16_f32 v25, v104, v104
    v_lshlrev_b32 v104, 16, v25
    v_cvt_pk_bf16_f32 v25, v105, v105
    v_lshlrev_b32 v105, 16, v25
    v_add_f32 v105, v105, v24
    v_cvt_pk_bf16_f32 v25, v105, v105
    v_lshlrev_b32 v105, 16, v25
    v_cvt_pk_bf16_f32 v25, v106, v106
    v_lshlrev_b32 v106, 16, v25
    v_add_f32 v106, v106, v24
    v_cvt_pk_bf16_f32 v25, v106, v106
    v_lshlrev_b32 v106, 16, v25
    v_cvt_pk_bf16_f32 v25, v107, v107
    v_lshlrev_b32 v107, 16, v25
    v_add_f32 v107, v107, v24
    v_cvt_pk_bf16_f32 v25, v107, v107
    v_lshlrev_b32 v107, 16, v25
    v_lshlrev_b32 v28, 16, v132
    v_mul_f32 v104, v104, v28
    v_and_b32 v28, 0xffff0000, v132
    v_mul_f32 v105, v105, v28
    v_lshlrev_b32 v28, 16, v133
    v_mul_f32 v106, v106, v28
    v_and_b32 v28, 0xffff0000, v133
    v_mul_f32 v107, v107, v28
    v_cvt_pk_bf16_f32 v104, v104, v105
    v_cvt_pk_bf16_f32 v105, v106, v107
    buffer_store_dwordx2 v[104:105], v161, s[20:23], 0 offen offset:32
    v_cvt_pk_bf16_f32 v25, v108, v108
    v_lshlrev_b32 v108, 16, v25
    v_add_f32 v108, v108, v24
    v_cvt_pk_bf16_f32 v25, v108, v108
    v_lshlrev_b32 v108, 16, v25
    v_cvt_pk_bf16_f32 v25, v109, v109
    v_lshlrev_b32 v109, 16, v25
    v_add_f32 v109, v109, v24
    v_cvt_pk_bf16_f32 v25, v109, v109
    v_lshlrev_b32 v109, 16, v25
    v_cvt_pk_bf16_f32 v25, v110, v110
    v_lshlrev_b32 v110, 16, v25
    v_add_f32 v110, v110, v24
    v_cvt_pk_bf16_f32 v25, v110, v110
    v_lshlrev_b32 v110, 16, v25
    v_cvt_pk_bf16_f32 v25, v111, v111
    v_lshlrev_b32 v111, 16, v25
    v_add_f32 v111, v111, v24
    v_cvt_pk_bf16_f32 v25, v111, v111
    v_lshlrev_b32 v111, 16, v25
    v_lshlrev_b32 v28, 16, v134
    v_mul_f32 v108, v108, v28
    v_and_b32 v28, 0xffff0000, v134
    v_mul_f32 v109, v109, v28
    v_lshlrev_b32 v28, 16, v135
    v_mul_f32 v110, v110, v28
    v_and_b32 v28, 0xffff0000, v135
    v_mul_f32 v111, v111, v28
    v_cvt_pk_bf16_f32 v108, v108, v109
    v_cvt_pk_bf16_f32 v109, v110, v111
    buffer_store_dwordx2 v[108:109], v161, s[20:23], 0 offen offset:48
    v_cvt_pk_bf16_f32 v25, v112, v112
    v_lshlrev_b32 v112, 16, v25
    v_add_f32 v112, v112, v24
    v_cvt_pk_bf16_f32 v25, v112, v112
    v_lshlrev_b32 v112, 16, v25
    v_cvt_pk_bf16_f32 v25, v113, v113
    v_lshlrev_b32 v113, 16, v25
    v_add_f32 v113, v113, v24
    v_cvt_pk_bf16_f32 v25, v113, v113
    v_lshlrev_b32 v113, 16, v25
    v_cvt_pk_bf16_f32 v25, v114, v114
    v_lshlrev_b32 v114, 16, v25
    v_add_f32 v114, v114, v24
    v_cvt_pk_bf16_f32 v25, v114, v114
    v_lshlrev_b32 v114, 16, v25
    v_cvt_pk_bf16_f32 v25, v115, v115
    v_lshlrev_b32 v115, 16, v25
    v_add_f32 v115, v115, v24
    v_cvt_pk_bf16_f32 v25, v115, v115
    v_lshlrev_b32 v115, 16, v25
    v_lshlrev_b32 v28, 16, v136
    v_mul_f32 v112, v112, v28
    v_and_b32 v28, 0xffff0000, v136
    v_mul_f32 v113, v113, v28
    v_lshlrev_b32 v28, 16, v137
    v_mul_f32 v114, v114, v28
    v_and_b32 v28, 0xffff0000, v137
    v_mul_f32 v115, v115, v28
    v_cvt_pk_bf16_f32 v112, v112, v113
    v_cvt_pk_bf16_f32 v113, v114, v115
    buffer_store_dwordx2 v[112:113], v161, s[20:23], 0 offen offset:64
    v_cvt_pk_bf16_f32 v25, v116, v116
    v_lshlrev_b32 v116, 16, v25
    v_add_f32 v116, v116, v24
    v_cvt_pk_bf16_f32 v25, v116, v116
    v_lshlrev_b32 v116, 16, v25
    v_cvt_pk_bf16_f32 v25, v117, v117
    v_lshlrev_b32 v117, 16, v25
    v_add_f32 v117, v117, v24
    v_cvt_pk_bf16_f32 v25, v117, v117
    v_lshlrev_b32 v117, 16, v25
    v_cvt_pk_bf16_f32 v25, v118, v118
    v_lshlrev_b32 v118, 16, v25
    v_add_f32 v118, v118, v24
    v_cvt_pk_bf16_f32 v25, v118, v118
    v_lshlrev_b32 v118, 16, v25
    v_cvt_pk_bf16_f32 v25, v119, v119
    v_lshlrev_b32 v119, 16, v25
    v_add_f32 v119, v119, v24
    v_cvt_pk_bf16_f32 v25, v119, v119
    v_lshlrev_b32 v119, 16, v25
    v_lshlrev_b32 v28, 16, v138
    v_mul_f32 v116, v116, v28
    v_and_b32 v28, 0xffff0000, v138
    v_mul_f32 v117, v117, v28
    v_lshlrev_b32 v28, 16, v139
    v_mul_f32 v118, v118, v28
    v_and_b32 v28, 0xffff0000, v139
    v_mul_f32 v119, v119, v28
    v_cvt_pk_bf16_f32 v116, v116, v117
    v_cvt_pk_bf16_f32 v117, v118, v119
    buffer_store_dwordx2 v[116:117], v161, s[20:23], 0 offen offset:80
    v_cvt_pk_bf16_f32 v25, v120, v120
    v_lshlrev_b32 v120, 16, v25
    v_add_f32 v120, v120, v24
    v_cvt_pk_bf16_f32 v25, v120, v120
    v_lshlrev_b32 v120, 16, v25
    v_cvt_pk_bf16_f32 v25, v121, v121
    v_lshlrev_b32 v121, 16, v25
    v_add_f32 v121, v121, v24
    v_cvt_pk_bf16_f32 v25, v121, v121
    v_lshlrev_b32 v121, 16, v25
    v_cvt_pk_bf16_f32 v25, v122, v122
    v_lshlrev_b32 v122, 16, v25
    v_add_f32 v122, v122, v24
    v_cvt_pk_bf16_f32 v25, v122, v122
    v_lshlrev_b32 v122, 16, v25
    v_cvt_pk_bf16_f32 v25, v123, v123
    v_lshlrev_b32 v123, 16, v25
    v_add_f32 v123, v123, v24
    v_cvt_pk_bf16_f32 v25, v123, v123
    v_lshlrev_b32 v123, 16, v25
    v_lshlrev_b32 v28, 16, v140
    v_mul_f32 v120, v120, v28
    v_and_b32 v28, 0xffff0000, v140
    v_mul_f32 v121, v121, v28
    v_lshlrev_b32 v28, 16, v141
    v_mul_f32 v122, v122, v28
    v_and_b32 v28, 0xffff0000, v141
    v_mul_f32 v123, v123, v28
    v_cvt_pk_bf16_f32 v120, v120, v121
    v_cvt_pk_bf16_f32 v121, v122, v123
    buffer_store_dwordx2 v[120:121], v161, s[20:23], 0 offen offset:96
    v_cvt_pk_bf16_f32 v25, v124, v124
    v_lshlrev_b32 v124, 16, v25
    v_add_f32 v124, v124, v24
    v_cvt_pk_bf16_f32 v25, v124, v124
    v_lshlrev_b32 v124, 16, v25
    v_cvt_pk_bf16_f32 v25, v125, v125
    v_lshlrev_b32 v125, 16, v25
    v_add_f32 v125, v125, v24
    v_cvt_pk_bf16_f32 v25, v125, v125
    v_lshlrev_b32 v125, 16, v25
    v_cvt_pk_bf16_f32 v25, v126, v126
    v_lshlrev_b32 v126, 16, v25
    v_add_f32 v126, v126, v24
    v_cvt_pk_bf16_f32 v25, v126, v126
    v_lshlrev_b32 v126, 16, v25
    v_cvt_pk_bf16_f32 v25, v127, v127
    v_lshlrev_b32 v127, 16, v25
    v_add_f32 v127, v127, v24
    v_cvt_pk_bf16_f32 v25, v127, v127
    v_lshlrev_b32 v127, 16, v25
    v_lshlrev_b32 v28, 16, v142
    v_mul_f32 v124, v124, v28
    v_and_b32 v28, 0xffff0000, v142
    v_mul_f32 v125, v125, v28
    v_lshlrev_b32 v28, 16, v143
    v_mul_f32 v126, v126, v28
    v_and_b32 v28, 0xffff0000, v143
    v_mul_f32 v127, v127, v28
    v_cvt_pk_bf16_f32 v124, v124, v125
    v_cvt_pk_bf16_f32 v125, v126, v127
    buffer_store_dwordx2 v[124:125], v161, s[20:23], 0 offen offset:112
gemm2_kernel_end:
    s_endpgm
.globl gemm3_kernel
.p2align 8
.type gemm3_kernel,@function
gemm3_kernel:
    s_cmp_ge_u32 s2, 224
    s_cbranch_scc1 gemm3_kernel_end
    s_load_dwordx16 s[64:79], s[0:1], 0
    s_load_dwordx8 s[80:87], s[0:1], 64
    s_load_dwordx4 s[88:91], s[0:1], 96
    s_waitcnt lgkmcnt(0)
    s_add_u32 s8, s90, 10485760
    s_addc_u32 s9, s91, 0
    s_mov_b32 s10, 802816
    s_mov_b32 s11, 0x00020000
    s_add_u32 s12, s90, 25165824
    s_addc_u32 s13, s91, 0
    s_mov_b32 s14, 3670016
    s_mov_b32 s15, 0x00020000
    s_and_b32 s5, s2, 31
    s_lshr_b32 s4, s2, 5
    s_lshl_b32 s4, s4, 6
    s_lshl_b32 s5, s5, 6
    s_mov_b32 s26, 1792
    s_mov_b32 s27, 1792
    v_lshrrev_b32 v15, 6, v0
    v_and_b32 v1, 63, v0
    v_lshrrev_b32 v2, 3, v1
    v_and_b32 v3, 7, v1
    s_nop 0
    v_readfirstlane_b32 s28, v15
    s_nop 3
    s_lshl_b32 s28, s28, 10
    v_lshlrev_b32 v20, 3, v15
    v_add_u32 v20, 0, v20
    v_add_u32 v20, v20, v2
    v_bfe_u32 v21, v20, 1, 3
    v_xor_b32 v21, v21, v3
    v_lshlrev_b32 v21, 4, v21
    v_add_u32 v20, s4, v20
    v_mul_lo_u32 v20, v20, s26
    v_add_u32 v24, v20, v21
    v_lshlrev_b32 v20, 3, v15
    v_add_u32 v20, 32, v20
    v_add_u32 v20, v20, v2
    v_bfe_u32 v21, v20, 1, 3
    v_xor_b32 v21, v21, v3
    v_lshlrev_b32 v21, 4, v21
    v_add_u32 v20, s4, v20
    v_mul_lo_u32 v20, v20, s26
    v_add_u32 v25, v20, v21
    v_lshlrev_b32 v20, 3, v15
    v_add_u32 v20, 0, v20
    v_add_u32 v20, v20, v2
    v_bfe_u32 v21, v20, 1, 3
    v_xor_b32 v21, v21, v3
    v_lshlrev_b32 v21, 4, v21
    v_add_u32 v20, s5, v20
    v_mul_lo_u32 v20, v20, s27
    v_add_u32 v26, v20, v21
    v_lshlrev_b32 v20, 3, v15
    v_add_u32 v20, 32, v20
    v_add_u32 v20, v20, v2
    v_bfe_u32 v21, v20, 1, 3
    v_xor_b32 v21, v21, v3
    v_lshlrev_b32 v21, 4, v21
    v_add_u32 v20, s5, v20
    v_mul_lo_u32 v20, v20, s27
    v_add_u32 v27, v20, v21
    v_and_b32 v13, 31, v0
    v_bfe_u32 v14, v0, 5, 1
    v_and_b32 v16, 1, v15
    v_lshrrev_b32 v17, 1, v15
    v_mul_u32_u24 v16, 32, v16
    v_mul_u32_u24 v17, 32, v17
    v_add_u32 v20, v16, v13
    v_bfe_u32 v21, v20, 1, 3
    v_and_b32 v22, 1, v21
    v_xor_b32 v22, v22, v14
    v_lshlrev_b32 v22, 4, v22
    v_lshlrev_b32 v20, 7, v20
    v_add_u32 v20, v20, v22
    v_add_u32 v20, 0, v20
    v_lshrrev_b32 v21, 1, v21
    v_xor_b32 v22, 0, v21
    v_lshlrev_b32 v22, 5, v22
    v_add_u32 v40, v20, v22
    v_xor_b32 v22, 1, v21
    v_lshlrev_b32 v22, 5, v22
    v_add_u32 v41, v20, v22
    v_xor_b32 v22, 2, v21
    v_lshlrev_b32 v22, 5, v22
    v_add_u32 v42, v20, v22
    v_xor_b32 v22, 3, v21
    v_lshlrev_b32 v22, 5, v22
    v_add_u32 v43, v20, v22
    v_add_u32 v20, v17, v13
    v_bfe_u32 v21, v20, 1, 3
    v_and_b32 v22, 1, v21
    v_xor_b32 v22, v22, v14
    v_lshlrev_b32 v22, 4, v22
    v_lshlrev_b32 v20, 7, v20
    v_add_u32 v20, v20, v22
    v_add_u32 v20, 8192, v20
    v_lshrrev_b32 v21, 1, v21
    v_xor_b32 v22, 0, v21
    v_lshlrev_b32 v22, 5, v22
    v_add_u32 v44, v20, v22
    v_xor_b32 v22, 1, v21
    v_lshlrev_b32 v22, 5, v22
    v_add_u32 v45, v20, v22
    v_xor_b32 v22, 2, v21
    v_lshlrev_b32 v22, 5, v22
    v_add_u32 v46, v20, v22
    v_xor_b32 v22, 3, v21
    v_lshlrev_b32 v22, 5, v22
    v_add_u32 v47, v20, v22
    v_mov_b32 v96, 0
    v_mov_b32 v97, 0
    v_mov_b32 v98, 0
    v_mov_b32 v99, 0
    v_mov_b32 v100, 0
    v_mov_b32 v101, 0
    v_mov_b32 v102, 0
    v_mov_b32 v103, 0
    v_mov_b32 v104, 0
    v_mov_b32 v105, 0
    v_mov_b32 v106, 0
    v_mov_b32 v107, 0
    v_mov_b32 v108, 0
    v_mov_b32 v109, 0
    v_mov_b32 v110, 0
    v_mov_b32 v111, 0
    s_mul_i32 s6, s2, 5
    s_lshr_b32 s33, s2, 3
    s_add_u32 s6, s6, s33
    s_mul_hi_u32 s33, s6, 306783379
    s_mul_i32 s33, s33, 14
    s_sub_u32 s6, s6, s33
    s_lshl_b32 s6, s6, 7
    s_mov_b32 s29, s28
    s_add_u32 s30, s28, 65536
    s_mov_b32 s31, 0
    s_mov_b32 s34, 4294918144
    s_mov_b32 s35, 16384
    s_add_u32 s16, s90, 4194304
    s_addc_u32 s17, s91, 0
    s_mov_b32 s18, 1835008
    s_mov_b32 s19, 0x00020000
    s_add_u32 s20, s86, 0
    s_addc_u32 s21, s87, 0
    s_mov_b32 s22, 1835008
    s_mov_b32 s23, 0x00020000
    v_add_u32 v3, v17, v13
    v_add_u32 v3, s5, v3
    v_lshlrev_b32 v20, 2, v14
    v_add_u32 v20, v20, v16
    v_add_u32 v20, s4, v20
    v_lshlrev_b32 v20, 1, v20
    v_mul_u32_u24 v3, 896, v3
    v_add_u32 v145, v3, v20
    buffer_load_dwordx2 v[112:113], v145, s[16:19], 0 offen offset:0
    buffer_load_dwordx2 v[114:115], v145, s[16:19], 0 offen offset:16
    buffer_load_dwordx2 v[116:117], v145, s[16:19], 0 offen offset:32
    buffer_load_dwordx2 v[118:119], v145, s[16:19], 0 offen offset:48
    s_add_u32 m0, s29, 0
    s_nop 0
    buffer_load_dwordx4 v24, s[8:11], s6 offen lds
    s_add_u32 m0, s29, 4096
    s_nop 0
    buffer_load_dwordx4 v25, s[8:11], s6 offen lds
    s_add_u32 m0, s29, 8192
    s_nop 0
    buffer_load_dwordx4 v26, s[12:15], s6 offen lds
    s_add_u32 m0, s29, 12288
    s_nop 0
    buffer_load_dwordx4 v27, s[12:15], s6 offen lds
    s_add_u32 s6, s6, 128
    s_cmp_ge_u32 s6, 1792
    s_cselect_b32 s6, 0, s6
    s_add_u32 s29, s29, 16384
    s_cmp_ge_u32 s29, s30
    s_cselect_b32 s29, s28, s29
    s_add_u32 m0, s29, 0
    s_nop 0
    buffer_load_dwordx4 v24, s[8:11], s6 offen lds
    s_add_u32 m0, s29, 4096
    s_nop 0
    buffer_load_dwordx4 v25, s[8:11], s6 offen lds
    s_add_u32 m0, s29, 8192
    s_nop 0
    buffer_load_dwordx4 v26, s[12:15], s6 offen lds
    s_add_u32 m0, s29, 12288
    s_nop 0
    buffer_load_dwordx4 v27, s[12:15], s6 offen lds
    s_add_u32 s6, s6, 128
    s_cmp_ge_u32 s6, 1792
    s_cselect_b32 s6, 0, s6
    s_add_u32 s29, s29, 16384
    s_cmp_ge_u32 s29, s30
    s_cselect_b32 s29, s28, s29
    s_add_u32 m0, s29, 0
    s_nop 0
    buffer_load_dwordx4 v24, s[8:11], s6 offen lds
    s_add_u32 m0, s29, 4096
    s_nop 0
    buffer_load_dwordx4 v25, s[8:11], s6 offen lds
    s_add_u32 m0, s29, 8192
    s_nop 0
    buffer_load_dwordx4 v26, s[12:15], s6 offen lds
    s_add_u32 m0, s29, 12288
    s_nop 0
    buffer_load_dwordx4 v27, s[12:15], s6 offen lds
    s_add_u32 s6, s6, 128
    s_cmp_ge_u32 s6, 1792
    s_cselect_b32 s6, 0, s6
    s_add_u32 s29, s29, 16384
    s_cmp_ge_u32 s29, s30
    s_cselect_b32 s29, s28, s29
    s_waitcnt vmcnt(8)
    s_barrier
    s_mov_b32 s7, 0
gemm3_kernel_loop:
    ds_read_b128 v[48:51], v40 offset:0
    ds_read_b128 v[56:59], v44 offset:0
    ds_read_b128 v[52:55], v41 offset:0
    ds_read_b128 v[60:63], v45 offset:0
    s_waitcnt lgkmcnt(2)
    v_mfma_f32_32x32x16_bf16 v[96:111], v[48:51], v[56:59], v[96:111]
    s_add_u32 m0, s29, 0
    s_nop 0
    buffer_load_dwordx4 v24, s[8:11], s6 offen lds
    ds_read_b128 v[48:51], v42 offset:0
    ds_read_b128 v[56:59], v46 offset:0
    s_waitcnt lgkmcnt(2)
    v_mfma_f32_32x32x16_bf16 v[96:111], v[52:55], v[60:63], v[96:111]
    s_add_u32 m0, s29, 4096
    s_nop 0
    buffer_load_dwordx4 v25, s[8:11], s6 offen lds
    ds_read_b128 v[52:55], v43 offset:0
    ds_read_b128 v[60:63], v47 offset:0
    s_waitcnt lgkmcnt(2)
    v_mfma_f32_32x32x16_bf16 v[96:111], v[48:51], v[56:59], v[96:111]
    s_add_u32 m0, s29, 8192
    s_nop 0
    buffer_load_dwordx4 v26, s[12:15], s6 offen lds
    s_waitcnt lgkmcnt(0)
    v_mfma_f32_32x32x16_bf16 v[96:111], v[52:55], v[60:63], v[96:111]
    s_add_u32 m0, s29, 12288
    s_nop 0
    buffer_load_dwordx4 v27, s[12:15], s6 offen lds
    s_add_u32 s6, s6, 128
    s_cmp_ge_u32 s6, 1792
    s_cselect_b32 s6, 0, s6
    s_add_u32 s29, s29, 16384
    s_cmp_ge_u32 s29, s30
    s_cselect_b32 s29, s28, s29
    s_add_u32 s31, s31, 1
    s_cmp_eq_u32 s31, 4
    s_cselect_b32 s33, s34, s35
    s_cselect_b32 s31, 0, s31
    v_add_u32 v40, s33, v40
    v_add_u32 v44, s33, v44
    v_add_u32 v41, s33, v41
    v_add_u32 v45, s33, v45
    v_add_u32 v42, s33, v42
    v_add_u32 v46, s33, v46
    v_add_u32 v43, s33, v43
    v_add_u32 v47, s33, v47
    s_waitcnt vmcnt(8)
    s_barrier
    s_add_u32 s7, s7, 1
    s_cmp_lt_u32 s7, 14
    s_cbranch_scc1 gemm3_kernel_loop
    s_waitcnt vmcnt(0)
    s_nop 15
    s_nop 3
    v_cvt_pk_bf16_f32 v25, v96, v96
    v_lshlrev_b32 v96, 16, v25
    v_cvt_pk_bf16_f32 v25, v97, v97
    v_lshlrev_b32 v97, 16, v25
    v_cvt_pk_bf16_f32 v25, v98, v98
    v_lshlrev_b32 v98, 16, v25
    v_cvt_pk_bf16_f32 v25, v99, v99
    v_lshlrev_b32 v99, 16, v25
    v_lshlrev_b32 v28, 16, v112
    v_add_f32 v96, v96, v28
    v_and_b32 v28, 0xffff0000, v112
    v_add_f32 v97, v97, v28
    v_lshlrev_b32 v28, 16, v113
    v_add_f32 v98, v98, v28
    v_and_b32 v28, 0xffff0000, v113
    v_add_f32 v99, v99, v28
    v_cvt_pk_bf16_f32 v96, v96, v97
    v_cvt_pk_bf16_f32 v97, v98, v99
    buffer_store_dwordx2 v[96:97], v145, s[20:23], 0 offen offset:0
    v_cvt_pk_bf16_f32 v25, v100, v100
    v_lshlrev_b32 v100, 16, v25
    v_cvt_pk_bf16_f32 v25, v101, v101
    v_lshlrev_b32 v101, 16, v25
    v_cvt_pk_bf16_f32 v25, v102, v102
    v_lshlrev_b32 v102, 16, v25
    v_cvt_pk_bf16_f32 v25, v103, v103
    v_lshlrev_b32 v103, 16, v25
    v_lshlrev_b32 v28, 16, v114
    v_add_f32 v100, v100, v28
    v_and_b32 v28, 0xffff0000, v114
    v_add_f32 v101, v101, v28
    v_lshlrev_b32 v28, 16, v115
    v_add_f32 v102, v102, v28
    v_and_b32 v28, 0xffff0000, v115
    v_add_f32 v103, v103, v28
    v_cvt_pk_bf16_f32 v100, v100, v101
    v_cvt_pk_bf16_f32 v101, v102, v103
    buffer_store_dwordx2 v[100:101], v145, s[20:23], 0 offen offset:16
    v_cvt_pk_bf16_f32 v25, v104, v104
    v_lshlrev_b32 v104, 16, v25
    v_cvt_pk_bf16_f32 v25, v105, v105
    v_lshlrev_b32 v105, 16, v25
    v_cvt_pk_bf16_f32 v25, v106, v106
    v_lshlrev_b32 v106, 16, v25
    v_cvt_pk_bf16_f32 v25, v107, v107
    v_lshlrev_b32 v107, 16, v25
    v_lshlrev_b32 v28, 16, v116
    v_add_f32 v104, v104, v28
    v_and_b32 v28, 0xffff0000, v116
    v_add_f32 v105, v105, v28
    v_lshlrev_b32 v28, 16, v117
    v_add_f32 v106, v106, v28
    v_and_b32 v28, 0xffff0000, v117
    v_add_f32 v107, v107, v28
    v_cvt_pk_bf16_f32 v104, v104, v105
    v_cvt_pk_bf16_f32 v105, v106, v107
    buffer_store_dwordx2 v[104:105], v145, s[20:23], 0 offen offset:32
    v_cvt_pk_bf16_f32 v25, v108, v108
    v_lshlrev_b32 v108, 16, v25
    v_cvt_pk_bf16_f32 v25, v109, v109
    v_lshlrev_b32 v109, 16, v25
    v_cvt_pk_bf16_f32 v25, v110, v110
    v_lshlrev_b32 v110, 16, v25
    v_cvt_pk_bf16_f32 v25, v111, v111
    v_lshlrev_b32 v111, 16, v25
    v_lshlrev_b32 v28, 16, v118
    v_add_f32 v108, v108, v28
    v_and_b32 v28, 0xffff0000, v118
    v_add_f32 v109, v109, v28
    v_lshlrev_b32 v28, 16, v119
    v_add_f32 v110, v110, v28
    v_and_b32 v28, 0xffff0000, v119
    v_add_f32 v111, v111, v28
    v_cvt_pk_bf16_f32 v108, v108, v109
    v_cvt_pk_bf16_f32 v109, v110, v111
    buffer_store_dwordx2 v[108:109], v145, s[20:23], 0 offen offset:48
gemm3_kernel_end:
    s_endpgm
.p2align 8
.section .rodata,"a"
.p2align 6
.amdhsa_kernel prep_kernel
  .amdhsa_next_free_vgpr 96
  .amdhsa_next_free_sgpr 102
  .amdhsa_accum_offset 96
  .amdhsa_group_segment_fixed_size 0
  .amdhsa_kernarg_size 112
  .amdhsa_user_sgpr_count 2
  .amdhsa_user_sgpr_kernarg_segment_ptr 1
  .amdhsa_system_sgpr_workgroup_id_x 1
.end_amdhsa_kernel
.p2align 6
.amdhsa_kernel conv_kernel
  .amdhsa_next_free_vgpr 112
  .amdhsa_next_free_sgpr 102
  .amdhsa_accum_offset 112
  .amdhsa_group_segment_fixed_size 0
  .amdhsa_kernarg_size 112
  .amdhsa_user_sgpr_count 2
  .amdhsa_user_sgpr_kernarg_segment_ptr 1
  .amdhsa_system_sgpr_workgroup_id_x 1
.end_amdhsa_kernel
.p2align 6
.amdhsa_kernel hln_kernel
  .amdhsa_next_free_vgpr 48
  .amdhsa_next_free_sgpr 102
  .amdhsa_accum_offset 48
  .amdhsa_group_segment_fixed_size 0
  .amdhsa_kernarg_size 112
  .amdhsa_user_sgpr_count 2
  .amdhsa_user_sgpr_kernarg_segment_ptr 1
  .amdhsa_system_sgpr_workgroup_id_x 1
.end_amdhsa_kernel
.p2align 6
.amdhsa_kernel gemm1_kernel
  .amdhsa_next_free_vgpr 128
  .amdhsa_next_free_sgpr 102
  .amdhsa_accum_offset 128
  .amdhsa_group_segment_fixed_size 0
  .amdhsa_kernarg_size 112
  .amdhsa_user_sgpr_count 2
  .amdhsa_user_sgpr_kernarg_segment_ptr 1
  .amdhsa_system_sgpr_workgroup_id_x 1
.end_amdhsa_kernel
.p2align 6
.amdhsa_kernel ln2_kernel
  .amdhsa_next_free_vgpr 48
  .amdhsa_next_free_sgpr 102
  .amdhsa_accum_offset 48
  .amdhsa_group_segment_fixed_size 0
  .amdhsa_kernarg_size 112
  .amdhsa_user_sgpr_count 2
  .amdhsa_user_sgpr_kernarg_segment_ptr 1
  .amdhsa_system_sgpr_workgroup_id_x 1
.end_amdhsa_kernel
.p2align 6
.amdhsa_kernel gemm2_kernel
  .amdhsa_next_free_vgpr 168
  .amdhsa_next_free_sgpr 102
  .amdhsa_accum_offset 168
  .amdhsa_group_segment_fixed_size 0
  .amdhsa_kernarg_size 112
  .amdhsa_user_sgpr_count 2
  .amdhsa_user_sgpr_kernarg_segment_ptr 1
  .amdhsa_system_sgpr_workgroup_id_x 1
.end_amdhsa_kernel
.p2align 6
.amdhsa_kernel gemm3_kernel
  .amdhsa_next_free_vgpr 152
  .amdhsa_next_free_sgpr 102
  .amdhsa_accum_offset 152
  .amdhsa_group_segment_fixed_size 0
  .amdhsa_kernarg_size 112
  .amdhsa_user_sgpr_count 2
  .amdhsa_user_sgpr_kernarg_segment_ptr 1
  .amdhsa_system_sgpr_workgroup_id_x 1
.end_amdhsa_kernel
```
